```python
import torch

def _softmax(x, axis=-1):
    return torch.softmax(x, dim=axis)
def _gelu(x):
    return torch.nn.functional.gelu(x, approximate="tanh")
def _silu(x):
    return torch.nn.functional.silu(x)
def _sigmoid(x):
    return torch.sigmoid(x)
def _layernorm(x, axis=-1, eps=1e-5):
    m = x.mean(dim=axis, keepdim=True)
    v = x.var(dim=axis, keepdim=True, unbiased=False)
    return (x - m) / torch.sqrt(v + eps)
def _scatter_add(tgt, idx, src, axis=0):
    return tgt.clone().index_add_(axis, idx, src)
def _segment_sum(src, seg, n):
    out = torch.zeros((n,) + src.shape[1:], dtype=src.dtype)
    return out.index_add_(0, seg, src)
def _pad(x, pw):
    flat = tuple(v for pair in reversed(pw) for v in pair)
    return torch.nn.functional.pad(x, flat)

kernel_name = 'interleave_layers__gqa_block_cached__glu_gated_swiglu__decode'

def setup_inputs():

    _w = (lambda a: (lambda t: t.to(torch.bfloat16) if t.is_floating_point() else t)(torch.as_tensor(a)))
    def _A_setup():
        B, Sq, D = 4, 1, 576
        Hq, Hkv, Sk, Dh = 32, 16, 4096, 128
        assert Hq % Hkv == 0, (Hq, Hkv)
        return {
            "x": _w((lambda *s: torch.randn(*s, dtype=torch.bfloat16) * 0.05)(B, Sq, D)),
            "k_cache": _w((lambda *s: torch.randn(*s, dtype=torch.bfloat16) * 0.8)(B, Hkv, Sk, Dh)),
            "v_cache": _w((lambda *s: torch.randn(*s, dtype=torch.bfloat16) * 0.8)(B, Hkv, Sk, Dh)),
            "wq": _w((lambda *s: torch.randn(*s, dtype=torch.bfloat16) * 0.8)(D, Hq * Dh) * (D ** -0.5)),
            "wo": _w((lambda *s: torch.randn(*s, dtype=torch.bfloat16) * 0.8)(Hq * Dh, D) * ((Hq * Dh) ** -0.5)),
        }
    _A_in = _A_setup()

    def _B_setup():
        B, S, D, F = 4, 1, 576, 4608
        return {
            "x": _w((lambda *s: torch.randn(*s, dtype=torch.bfloat16) * 0.05)(B, S, D)),
            "w1": _w((lambda *s: torch.randn(*s, dtype=torch.bfloat16) * 0.2)(D, F) * (2.0 / D) ** 0.5),
            "w3": _w((lambda *s: torch.randn(*s, dtype=torch.bfloat16) * 0.2)(D, F) * (2.0 / D) ** 0.5),
            "w2": _w((lambda *s: torch.randn(*s, dtype=torch.bfloat16) * 0.2)(F, D) * (2.0 / F) ** 0.5),
        }
    _B_in = _B_setup()

    return {
        "A_x": _A_in["x"],
        "A_k_cache": _A_in["k_cache"],
        "A_v_cache": _A_in["v_cache"],
        "A_wq": _A_in["wq"],
        "A_wo": _A_in["wo"],
        "B_x": _B_in["x"],
        "B_w1": _B_in["w1"],
        "B_w3": _B_in["w3"],
        "B_w2": _B_in["w2"],
    }

def reference(A_x, A_k_cache, A_v_cache, A_wq, A_wo, B_x, B_w1, B_w3, B_w2):
    def _A_ref(x, k_cache, v_cache, wq, wo):
        B, Sq, D = x.shape
        Hq, Dh = 32, 128
        Hkv = k_cache.shape[1]
        rep = Hq // Hkv
        q = (lambda x, *d: x.permute(*d))((x @ wq).reshape(B, Sq, Hq, Dh), 0, 2, 1, 3)
        k = (lambda x, n, axis: torch.repeat_interleave(x, n, dim=axis))(k_cache, rep, axis=1)
        v = (lambda x, n, axis: torch.repeat_interleave(x, n, dim=axis))(v_cache, rep, axis=1)
        scores = torch.einsum("bhqd,bhkd->bhqk", q, k) * (Dh ** -0.5)
        p = _softmax(scores, axis=-1)
        o = torch.einsum("bhqk,bhkd->bhqd", p, v)
        return (lambda x, *d: x.permute(*d))(o, 0, 2, 1, 3).reshape(B, Sq, Hq * Dh) @ wo

    def _B_ref(x, w1, w3, w2):
        gate = torch.einsum("bsd,df->bsf", x, w1)
        up = torch.einsum("bsd,df->bsf", x, w3)
        h = _silu(gate) * up
        out = torch.einsum("bsf,fd->bsd", h, w2)
        return out

    x = A_x
    x = x + _A_ref(_layernorm(x, axis=-1), A_k_cache, A_v_cache, A_wq, A_wo)
    x = x + _B_ref(_layernorm(x, axis=-1), B_w1, B_w3, B_w2)
    x = x + _A_ref(_layernorm(x, axis=-1), A_k_cache, A_v_cache, A_wq, A_wo)
    x = x + _B_ref(_layernorm(x, axis=-1), B_w1, B_w3, B_w2)
    return x
```

```asm
; @launch grid=(256,1,1) block=(256,1,1) lds=163840
.amdgcn_target "amdgcn-amd-amdhsa--gfx950"
.text
.globl interleave_layers__gqa_block_cached__glu_gated_swiglu__decode_kernel
.p2align 8
.type interleave_layers__gqa_block_cached__glu_gated_swiglu__decode_kernel,@function
interleave_layers__gqa_block_cached__glu_gated_swiglu__decode_kernel:
s_cmp_ge_u32 s2, 256
s_cbranch_scc1 L_end
s_load_dwordx16 s[72:87], s[0:1], 0
s_load_dwordx8 s[88:95], s[0:1], 64
v_lshrrev_b32 v1, 6, v0
v_and_b32 v0, 63, v0
v_readfirstlane_b32 s3, v1
v_lshlrev_b32 v1, 4, v0
v_mov_b32 v5, 0
s_and_b32 s48, s2, 7
s_lshr_b32 s49, s2, 3
s_bfe_u32 s55, s49, 0x20002
s_lshl_b32 s55, s55, 4
s_lshl_b32 s56, s48, 1
s_add_u32 s55, s55, s56
s_lshr_b32 s56, s49, 4
s_add_u32 s55, s55, s56
s_lshl_b32 s54, s55, 20
s_and_b32 s56, s49, 3
s_lshl_b32 s56, s56, 14
s_add_u32 s54, s54, s56
s_lshl_b32 s56, s3, 12
s_add_u32 s54, s54, s56
s_lshl_b32 s70, s3, 15
v_and_b32 v10, 15, v0
v_lshrrev_b32 v11, 4, v0
v_lshlrev_b32 v6, 8, v10
v_lshl_add_u32 v6, v11, 4, v6
v_lshlrev_b32 v12, 1, v11
v_xor_b32 v12, v12, v10
v_lshlrev_b32 v7, 4, v12
v_lshl_add_u32 v7, v11, 8, v7
v_xor_b32 v8, 0x80, v7
s_waitcnt lgkmcnt(0)
s_mov_b32 s4, s74
s_and_b32 s5, s75, 0xffff
s_mov_b32 s6, 67108864
s_mov_b32 s7, 0x20000
s_getpc_b64 s[98:99]
L_pc:
s_lshl_b32 s55, s49, 2
s_add_u32 s55, s55, s3
s_lshl_b32 s55, s55, 10
s_cmp_lt_u32 s55, L_code_end-L_pc-1024
s_cbranch_scc0 Lcw_1
v_add_u32 v13, s55, v1
global_load_dwordx4 v[120:123], v13, s[98:99]
Lcw_1:
s_add_u32 s55, s54, 0
buffer_load_dwordx4 a[0:3], v6, s[4:7], s55 offen offset:0 nt
buffer_load_dwordx4 a[4:7], v6, s[4:7], s55 offen offset:64 nt
buffer_load_dwordx4 a[8:11], v6, s[4:7], s55 offen offset:128 nt
buffer_load_dwordx4 a[12:15], v6, s[4:7], s55 offen offset:192 nt
s_mov_b32 s8, s76
s_and_b32 s9, s77, 0xffff
s_mov_b32 s10, 67108864
s_mov_b32 s11, 0x20000
s_mov_b32 s40, s94
s_and_b32 s41, s95, 0xffff
s_mov_b32 s42, 8388608
s_mov_b32 s43, 0x20000
s_add_u32 s55, s54, 65536
buffer_load_dwordx4 a[16:19], v6, s[4:7], s55 offen offset:0 nt
buffer_load_dwordx4 a[20:23], v6, s[4:7], s55 offen offset:64 nt
buffer_load_dwordx4 a[24:27], v6, s[4:7], s55 offen offset:128 nt
buffer_load_dwordx4 a[28:31], v6, s[4:7], s55 offen offset:192 nt
s_mov_b32 s12, s78
s_and_b32 s13, s79, 0xffff
s_mov_b32 s14, 4718592
s_mov_b32 s15, 0x20000
s_mov_b32 s16, s80
s_and_b32 s17, s81, 0xffff
s_mov_b32 s18, 4718592
s_mov_b32 s19, 0x20000
s_mov_b32 s20, s84
s_and_b32 s21, s85, 0xffff
s_mov_b32 s22, 5308416
s_mov_b32 s23, 0x20000
s_mov_b32 s24, s86
s_and_b32 s25, s87, 0xffff
s_mov_b32 s26, 5308416
s_mov_b32 s27, 0x20000
s_mov_b32 s28, s88
s_and_b32 s29, s89, 0xffff
s_mov_b32 s30, 5308416
s_mov_b32 s31, 0x20000
s_mov_b32 s32, s72
s_and_b32 s33, s73, 0xffff
s_mov_b32 s34, 4608
s_mov_b32 s35, 0x20000
s_mov_b32 s36, s90
s_and_b32 s37, s91, 0xffff
s_mov_b32 s38, 4608
s_mov_b32 s39, 0x20000
s_mov_b32 s44, s92
s_and_b32 s45, s93, 0xffff
s_mov_b32 s46, 256
s_mov_b32 s47, 0x20000
v_mov_b32 v124, -1
v_mov_b32 v125, -1
v_mov_b32 v126, -1
v_mov_b32 v127, -1
s_mul_i32 s53, s48, 73728
s_mul_i32 s55, s49, 2304
s_add_u32 s72, s55, s53
s_mul_i32 s56, s3, 576
s_add_u32 s72, s72, s56
s_mov_b32 exec_hi, 15
buffer_store_dwordx4 v[124:127], v1, s[40:43], s72 offen
s_mov_b64 exec, -1
s_cmp_lt_u32 s3, 2
s_cbranch_scc0 Lw_2
s_mul_i32 s55, s2, 1152
s_lshl_b32 s56, s3, 10
s_add_u32 s56, s56, s55
s_add_u32 s56, s56, 589824
s_cmp_eq_u32 s3, 0
s_cselect_b64 exec, -1, 0xff
buffer_store_dwordx4 v[124:127], v1, s[40:43], s56 offen sc1 nt
s_mov_b64 exec, -1
Lw_2:
s_lshr_b32 s55, s49, 4
s_lshl_b32 s55, s55, 9
s_bfe_u32 s65, s49, 0x10003
s_lshl_b32 s65, s65, 4
s_add_u32 s65, s65, s55
s_add_u32 s65, s65, s53
s_mov_b32 s96, 0x000f000f
s_mov_b32 s97, 0x000f000f
s_lshl_b32 s99, s48, 14
s_add_u32 s99, s99, 2097152
s_lshl_b32 s55, s49, 10
s_add_u32 s71, s99, s55
s_lshl_b32 s55, s3, 8
s_add_u32 s71, s71, s55
s_bfe_u32 s55, s49, 0x20002
s_lshl_b32 s55, s55, 4
s_add_u32 s99, s99, s55
s_lshr_b32 s55, s49, 4
s_lshl_b32 s55, s55, 12
s_add_u32 s99, s99, s55
s_and_b32 s55, s3, 1
s_lshl_b32 s55, s55, 13
s_add_u32 s99, s99, s55
s_cmp_lt_u32 s49, 16
s_cbranch_scc0 Lnq0_3
v_lshrrev_b32 v13, 4, v0
v_lshlrev_b32 v13, 6, v13
v_and_b32 v15, 3, v0
v_lshl_add_u32 v13, v15, 4, v13
s_mov_b64 exec, s[96:97]
buffer_store_dwordx4 v[124:127], v13, s[40:43], s71 offen sc1
s_mov_b64 exec, -1
s_bfe_u32 s63, s49, 0x10003
s_mul_i32 s63, s63, 2359296
s_lshl_b32 s55, s48, 10
s_add_u32 s63, s63, s55
s_and_b32 s55, s49, 7
s_lshl_b32 s55, s55, 7
s_add_u32 s63, s63, s55
v_lshrrev_b32 v5, 3, v0
s_mov_b32 s55, 8192
v_mul_lo_u32 v5, v5, s55
v_and_b32 v15, 7, v0
v_lshl_add_u32 v5, v15, 4, v5
s_mul_i32 s55, s3, 65536
s_add_u32 s61, s63, s55
s_add_u32 s63, s61, s55
s_add_u32 s61, s61, 2097152
s_lshl_b32 s56, s3, 11
s_add_u32 m0, s56, 131072
s_nop 0
buffer_load_dwordx4 v5, s[12:15], s63 offen nt lds
v_and_b32 v10, 3, v0
v_mul_u32_u24 v10, 1152, v10
v_lshrrev_b32 v11, 2, v0
v_lshl_add_u32 v10, v11, 4, v10
s_lshl_b32 s55, s3, 8
buffer_load_dwordx4 v[108:111], v10, s[32:35], s55 offen
buffer_load_dwordx4 v[112:115], v10, s[32:35], 0 offen offset:1024
Lnq0_3:
s_add_u32 s55, s54, 131072
buffer_load_dwordx4 a[32:35], v6, s[4:7], s55 offen offset:0 nt
buffer_load_dwordx4 a[36:39], v6, s[4:7], s55 offen offset:64 nt
buffer_load_dwordx4 a[40:43], v6, s[4:7], s55 offen offset:128 nt
buffer_load_dwordx4 a[44:47], v6, s[4:7], s55 offen offset:192 nt
s_cmp_lt_u32 s49, 16
s_cbranch_scc0 Lnq0_4
s_add_u32 s63, s63, 65536
s_lshl_b32 s56, s3, 11
s_add_u32 m0, s56, 132096
s_nop 0
buffer_load_dwordx4 v5, s[12:15], s63 offen nt lds
Lnq0_4:
s_add_u32 s55, s54, 0
s_add_u32 m0, s70, 0
s_nop 0
buffer_load_dwordx4 v7, s[8:11], s55 offen offset:0 nt lds
buffer_load_dwordx4 v8, s[8:11], s55 offen offset:1024 nt lds
buffer_load_dwordx4 v7, s[8:11], s55 offen offset:2048 nt lds
buffer_load_dwordx4 v8, s[8:11], s55 offen offset:3072 nt lds
s_cmp_lt_u32 s49, 16
s_cbranch_scc0 Lnq0_5
s_add_u32 s63, s63, 458752
s_lshl_b32 s56, s3, 11
s_add_u32 m0, s56, 139264
s_nop 0
buffer_load_dwordx4 v5, s[12:15], s63 offen nt lds
Lnq0_5:
s_mov_b32 s51, 2097152
s_mov_b32 s60, 0x3e0293ee
s_lshl_b32 s69, s3, 10
s_add_u32 s69, s69, s53
s_lshr_b32 s57, s49, 4
s_bfe_u32 s56, s49, 0x20002
s_lshl_b32 s64, s56, 10
s_lshl_b32 s55, s57, 9
s_add_u32 s64, s64, s55
s_add_u32 s64, s64, s53
s_and_b32 s55, s49, 3
s_lshl_b32 s55, s55, 2
s_add_u32 s55, s55, s56
s_lshl_b32 s55, s55, 4
s_add_u32 s55, s55, s53
s_lshl_b32 s66, s57, 13
s_add_u32 s66, s66, s55
s_add_u32 s66, s66, 4096
s_lshl_b32 s67, s57, 8
s_add_u32 s67, s67, s55
s_add_u32 s67, s67, 36864
s_cmp_lt_u32 s49, 18
s_cbranch_scc0 Lsw_6
s_cmp_ge_u32 s49, 9
s_cselect_b32 s62, 1, 0
s_mul_i32 s56, s62, 9
s_sub_u32 s56, s49, s56
s_lshl_b32 s56, s56, 2
s_add_u32 s56, s56, s3
s_branch Lse_7
Lsw_6:
s_cmp_ge_u32 s49, 24
s_cselect_b32 s62, 1, 0
s_mul_i32 s56, s62, 6
s_sub_u32 s56, s49, s56
s_sub_u32 s56, s56, 18
s_mul_i32 s56, s56, 6
s_lshl_b32 s57, s3, 1
s_add_u32 s55, s3, 2
s_min_u32 s57, s57, s55
s_add_u32 s56, s56, s57
Lse_7:
s_lshl_b32 s68, s56, 12
s_lshl_b32 s55, s48, 1
s_add_u32 s55, s55, s62
s_lshl_b32 s55, s55, 8
s_add_u32 s68, s68, s55
s_add_u32 s68, s68, 589824
v_lshrrev_b32 v10, 2, v0
v_and_b32 v11, 7, v10
v_lshlrev_b32 v2, 8, v10
v_lshl_add_u32 v2, v11, 5, v2
v_and_b32 v11, 3, v0
v_lshl_add_u32 v2, v11, 3, v2
v_add_u32 v2, s70, v2
v_lshrrev_b32 v10, 4, v0
v_lshlrev_b32 v3, 6, v10
v_lshl_add_u32 v3, v11, 4, v3
v_add_u32 v3, 147456, v3
s_lshl_b32 s56, s3, 11
s_add_u32 s56, s56, 155648
v_add_u32 v4, s56, v1
s_sub_u32 s55, s49, 18
s_cmp_lt_u32 s55, 12
s_cbranch_scc0 Lnwo_8
v_lshrrev_b32 v5, 4, v0
v_mul_u32_u24 v5, 1152, v5
v_and_b32 v15, 15, v0
v_lshl_add_u32 v5, v15, 4, v5
s_mul_i32 s56, s62, 6
s_sub_u32 s56, s49, s56
s_sub_u32 s56, s56, 18
s_mul_i32 s56, s56, 192
s_and_b32 s56, s56, 0xffffff80
s_lshl_b32 s57, s48, 1
s_add_u32 s57, s57, s62
s_mul_i32 s57, s57, 294912
s_add_u32 s56, s56, s57
s_mul_i32 s57, s3, 9216
s_add_u32 s56, s56, s57
s_mov_b32 s63, s56
s_lshl_b32 s56, s3, 11
s_add_u32 m0, s56, 131072
s_nop 0
buffer_load_dwordx4 v5, s[16:19], s63 offen nt lds
s_add_u32 s63, s63, 4608
s_lshl_b32 s56, s3, 11
s_add_u32 m0, s56, 132096
s_nop 0
buffer_load_dwordx4 v5, s[16:19], s63 offen nt lds
Lnwo_8:
s_add_u32 s55, s54, 196608
buffer_load_dwordx4 a[48:51], v6, s[4:7], s55 offen offset:0 nt
buffer_load_dwordx4 a[52:55], v6, s[4:7], s55 offen offset:64 nt
buffer_load_dwordx4 a[56:59], v6, s[4:7], s55 offen offset:128 nt
buffer_load_dwordx4 a[60:63], v6, s[4:7], s55 offen offset:192 nt
s_cmp_lt_u32 s49, 16
s_cbranch_scc0 Lnq0_9
s_add_u32 s63, s63, 65536
s_lshl_b32 s56, s3, 11
s_add_u32 m0, s56, 140288
s_nop 0
buffer_load_dwordx4 v5, s[12:15], s63 offen nt lds
Lnq0_9:
s_add_u32 s55, s54, 65536
s_add_u32 m0, s70, 4096
s_nop 0
buffer_load_dwordx4 v7, s[8:11], s55 offen offset:0 nt lds
buffer_load_dwordx4 v8, s[8:11], s55 offen offset:1024 nt lds
buffer_load_dwordx4 v7, s[8:11], s55 offen offset:2048 nt lds
buffer_load_dwordx4 v8, s[8:11], s55 offen offset:3072 nt lds
s_cmp_lt_u32 s49, 16
s_cbranch_scc0 Lnq0_10
s_add_u32 s63, s63, 458752
s_lshl_b32 s56, s3, 11
s_add_u32 m0, s56, 147456
s_nop 0
buffer_load_dwordx4 v5, s[12:15], s63 offen nt lds
Lnq0_10:
s_sub_u32 s55, s49, 18
s_cmp_lt_u32 s55, 12
s_cbranch_scc0 Lnwo_11
s_add_u32 s63, s63, 32256
s_lshl_b32 s56, s3, 11
s_add_u32 m0, s56, 139264
s_nop 0
buffer_load_dwordx4 v5, s[16:19], s63 offen nt lds
s_add_u32 s63, s63, 4608
s_lshl_b32 s56, s3, 11
s_add_u32 m0, s56, 140288
s_nop 0
buffer_load_dwordx4 v5, s[16:19], s63 offen nt lds
Lnwo_11:
s_add_u32 s55, s54, 262144
buffer_load_dwordx4 a[64:67], v6, s[4:7], s55 offen offset:0 nt
buffer_load_dwordx4 a[68:71], v6, s[4:7], s55 offen offset:64 nt
buffer_load_dwordx4 a[72:75], v6, s[4:7], s55 offen offset:128 nt
buffer_load_dwordx4 a[76:79], v6, s[4:7], s55 offen offset:192 nt
s_cmp_lt_u32 s49, 16
s_cbranch_scc0 Lnq0_12
s_add_u32 s63, s63, 65536
s_lshl_b32 s56, s3, 11
s_add_u32 m0, s56, 148480
s_nop 0
buffer_load_dwordx4 v5, s[12:15], s63 offen nt lds
Lnq0_12:
s_add_u32 s55, s54, 131072
s_add_u32 m0, s70, 8192
s_nop 0
buffer_load_dwordx4 v7, s[8:11], s55 offen offset:0 nt lds
buffer_load_dwordx4 v8, s[8:11], s55 offen offset:1024 nt lds
buffer_load_dwordx4 v7, s[8:11], s55 offen offset:2048 nt lds
buffer_load_dwordx4 v8, s[8:11], s55 offen offset:3072 nt lds
s_cmp_lt_u32 s49, 16
s_cbranch_scc0 Lnq0_13
s_add_u32 s63, s63, 458752
s_lshl_b32 s56, s3, 11
s_add_u32 m0, s56, 155648
s_nop 0
buffer_load_dwordx4 v5, s[12:15], s63 offen nt lds
Lnq0_13:
s_sub_u32 s55, s49, 18
s_cmp_lt_u32 s55, 12
s_cbranch_scc0 Lnwo_14
s_add_u32 s63, s63, 32256
s_lshl_b32 s56, s3, 11
s_add_u32 m0, s56, 147456
s_nop 0
buffer_load_dwordx4 v5, s[16:19], s63 offen nt lds
s_add_u32 s63, s63, 4608
s_lshl_b32 s56, s3, 11
s_add_u32 m0, s56, 148480
s_nop 0
buffer_load_dwordx4 v5, s[16:19], s63 offen nt lds
Lnwo_14:
s_waitcnt vmcnt(24)
s_barrier
s_cmp_eq_u32 s3, 0
s_cbranch_scc0 Lw_15
s_mov_b64 exec, 1
s_getreg_b32 s55, hwreg(HW_REG_XCC_ID, 0, 3)
s_lshl_b32 s55, s55, 3
s_lshl_b64 s[58:59], 1, s55
v_mov_b32 v12, s58
v_mov_b32 v13, s59
s_lshl_b32 s56, s48, 5
v_mov_b32 v11, s56
buffer_atomic_add_x2 v[12:13], v11, s[44:47], 0 offen sc1
s_mov_b64 exec, -1
Lw_15:
v_lshrrev_b32 v9, 3, v0
s_mov_b32 s55, 9216
v_mul_lo_u32 v9, v9, s55
v_and_b32 v15, 7, v0
v_lshl_add_u32 v9, v15, 4, v9
s_mul_i32 s55, s62, 9
s_sub_u32 s55, s49, s55
s_lshl_b32 s55, s55, 7
s_mul_i32 s98, s48, 1152
s_add_u32 s98, s98, s55
s_mul_i32 s55, s3, 147456
s_add_u32 s98, s98, s55
s_cmp_eq_u32 s62, 1
s_cselect_b32 s20, s24, s20
s_cselect_b32 s21, s25, s21
s_cmp_lt_u32 s49, 18
s_cbranch_scc0 LstreamW_16
s_add_u32 s55, s54, 327680
buffer_load_dwordx4 a[80:83], v6, s[4:7], s55 offen offset:0 nt
buffer_load_dwordx4 a[84:87], v6, s[4:7], s55 offen offset:64 nt
buffer_load_dwordx4 a[88:91], v6, s[4:7], s55 offen offset:128 nt
buffer_load_dwordx4 a[92:95], v6, s[4:7], s55 offen offset:192 nt
s_cmp_lt_u32 s49, 16
s_cbranch_scc0 Lnq0_18
s_add_u32 s63, s63, 65536
s_lshl_b32 s56, s3, 11
s_add_u32 m0, s56, 156672
s_nop 0
buffer_load_dwordx4 v5, s[12:15], s63 offen nt lds
Lnq0_18:
s_add_u32 s55, s54, 196608
s_add_u32 m0, s70, 12288
s_nop 0
buffer_load_dwordx4 v7, s[8:11], s55 offen offset:0 nt lds
buffer_load_dwordx4 v8, s[8:11], s55 offen offset:1024 nt lds
buffer_load_dwordx4 v7, s[8:11], s55 offen offset:2048 nt lds
buffer_load_dwordx4 v8, s[8:11], s55 offen offset:3072 nt lds
s_cmp_lt_u32 s49, 16
s_cbranch_scc0 Lnq0_19
s_lshl_b32 s56, s3, 10
s_add_u32 m0, s56, 28672
s_nop 0
buffer_load_dwordx4 v5, s[12:15], s61 offen nt lds
Lnq0_19:
s_add_u32 s55, s54, 393216
buffer_load_dwordx4 a[96:99], v6, s[4:7], s55 offen offset:0 nt
buffer_load_dwordx4 a[100:103], v6, s[4:7], s55 offen offset:64 nt
buffer_load_dwordx4 a[104:107], v6, s[4:7], s55 offen offset:128 nt
buffer_load_dwordx4 a[108:111], v6, s[4:7], s55 offen offset:192 nt
s_waitcnt vmcnt(20)
ds_read_b64_tr_b16 v[128:129], v2 offset:0
ds_read_b64_tr_b16 v[130:131], v2 offset:4096
v_xor_b32 v15, 32, v2
ds_read_b64_tr_b16 v[132:133], v15 offset:0
ds_read_b64_tr_b16 v[134:135], v15 offset:4096
v_xor_b32 v15, 64, v2
ds_read_b64_tr_b16 v[136:137], v15 offset:0
ds_read_b64_tr_b16 v[138:139], v15 offset:4096
v_xor_b32 v15, 96, v2
ds_read_b64_tr_b16 v[140:141], v15 offset:0
ds_read_b64_tr_b16 v[142:143], v15 offset:4096
v_xor_b32 v15, 128, v2
ds_read_b64_tr_b16 v[144:145], v15 offset:0
ds_read_b64_tr_b16 v[146:147], v15 offset:4096
v_xor_b32 v15, 160, v2
ds_read_b64_tr_b16 v[148:149], v15 offset:0
ds_read_b64_tr_b16 v[150:151], v15 offset:4096
v_xor_b32 v15, 192, v2
ds_read_b64_tr_b16 v[152:153], v15 offset:0
ds_read_b64_tr_b16 v[154:155], v15 offset:4096
v_xor_b32 v15, 224, v2
ds_read_b64_tr_b16 v[156:157], v15 offset:0
ds_read_b64_tr_b16 v[158:159], v15 offset:4096
s_waitcnt lgkmcnt(0)
s_add_u32 s55, s54, 262144
s_add_u32 m0, s70, 16384
s_nop 0
buffer_load_dwordx4 v7, s[8:11], s55 offen offset:0 nt lds
buffer_load_dwordx4 v8, s[8:11], s55 offen offset:1024 nt lds
buffer_load_dwordx4 v7, s[8:11], s55 offen offset:2048 nt lds
buffer_load_dwordx4 v8, s[8:11], s55 offen offset:3072 nt lds
s_add_u32 s55, s54, 458752
buffer_load_dwordx4 a[112:115], v6, s[4:7], s55 offen offset:0 nt
buffer_load_dwordx4 a[116:119], v6, s[4:7], s55 offen offset:64 nt
buffer_load_dwordx4 a[120:123], v6, s[4:7], s55 offen offset:128 nt
buffer_load_dwordx4 a[124:127], v6, s[4:7], s55 offen offset:192 nt
s_cmp_lt_u32 s49, 16
s_cbranch_scc0 Lnq0_20
s_waitcnt vmcnt(12)
v_lshrrev_b32 v14, 4, v0
v_bfe_u32 v15, v0, 2, 2
v_lshl_add_u32 v14, v14, 3, v15
v_lshlrev_b32 v10, 7, v14
v_and_b32 v15, 3, v0
v_lshl_add_u32 v10, v15, 3, v10
s_lshl_b32 s55, s3, 5
v_add_u32 v10, s55, v10
v_add_u32 v11, 131072, v10
s_barrier
ds_read_b64_tr_b16 v[72:73], v11 offset:0
ds_read_b64_tr_b16 v[74:75], v11 offset:512
ds_read_b64_tr_b16 v[76:77], v11 offset:4096
ds_read_b64_tr_b16 v[78:79], v11 offset:4608
ds_read_b64_tr_b16 v[80:81], v11 offset:8192
ds_read_b64_tr_b16 v[82:83], v11 offset:8704
ds_read_b64_tr_b16 v[84:85], v11 offset:12288
ds_read_b64_tr_b16 v[86:87], v11 offset:12800
ds_read_b64_tr_b16 v[88:89], v11 offset:16384
ds_read_b64_tr_b16 v[90:91], v11 offset:16896
ds_read_b64_tr_b16 v[92:93], v11 offset:20480
ds_read_b64_tr_b16 v[94:95], v11 offset:20992
ds_read_b64_tr_b16 v[96:97], v11 offset:24576
ds_read_b64_tr_b16 v[98:99], v11 offset:25088
ds_read_b64_tr_b16 v[100:101], v11 offset:28672
ds_read_b64_tr_b16 v[102:103], v11 offset:29184
ds_read_b64_tr_b16 v[104:105], v10 offset:28672
ds_read_b64_tr_b16 v[106:107], v10 offset:29184
s_waitcnt lgkmcnt(0)
s_barrier
v_mov_b32 v120, 0x3f803f80
v_mov_b32 v121, 0x3f803f80
v_mov_b32 v122, 0x3f803f80
v_mov_b32 v123, 0x3f803f80
s_nop 1
v_mfma_f32_16x16x32_bf16 v[116:119], v[72:75], v[120:123], 0
v_mfma_f32_16x16x32_bf16 v[116:119], v[76:79], v[120:123], v[116:119]
v_mfma_f32_16x16x32_bf16 v[116:119], v[80:83], v[120:123], v[116:119]
v_mfma_f32_16x16x32_bf16 v[116:119], v[84:87], v[120:123], v[116:119]
v_mfma_f32_16x16x32_bf16 v[116:119], v[88:91], v[120:123], v[116:119]
v_mfma_f32_16x16x32_bf16 v[116:119], v[92:95], v[120:123], v[116:119]
v_mfma_f32_16x16x32_bf16 v[116:119], v[96:99], v[120:123], v[116:119]
v_mfma_f32_16x16x32_bf16 v[116:119], v[100:103], v[120:123], v[116:119]
v_mfma_f32_16x16x32_bf16 v[116:119], v[104:107], v[120:123], v[116:119]
Lnq0_20:
s_add_u32 s55, s54, 327680
s_add_u32 m0, s70, 20480
s_nop 0
buffer_load_dwordx4 v7, s[8:11], s55 offen offset:0 nt lds
buffer_load_dwordx4 v8, s[8:11], s55 offen offset:1024 nt lds
buffer_load_dwordx4 v7, s[8:11], s55 offen offset:2048 nt lds
buffer_load_dwordx4 v8, s[8:11], s55 offen offset:3072 nt lds
s_cmp_lt_u32 s49, 16
s_cbranch_scc0 Lnq0_21
s_lshl_b32 s55, s3, 10
s_add_u32 s55, s55, 147456
v_add_u32 v11, s55, v1
s_lshl_b32 s55, s3, 5
s_add_u32 s55, s55, 152064
v_lshl_add_u32 v5, v0, 3, s55
v_mov_b32 v12, 0
v_mov_b32 v13, 0
v_mov_b32 v14, 0x3f803f80
ds_write_b128 v11, v[108:111]
v_dot2c_f32_bf16 v12, v108, v14
v_dot2c_f32_bf16 v13, v108, v108
v_dot2c_f32_bf16 v12, v109, v14
v_dot2c_f32_bf16 v13, v109, v109
v_dot2c_f32_bf16 v12, v110, v14
v_dot2c_f32_bf16 v13, v110, v110
v_dot2c_f32_bf16 v12, v111, v14
v_dot2c_f32_bf16 v13, v111, v111
s_cmp_eq_u32 s3, 0
s_cbranch_scc0 Lw_22
s_mov_b32 exec_hi, 0
ds_write_b128 v11, v[112:115] offset:4096
v_dot2c_f32_bf16 v12, v112, v14
v_dot2c_f32_bf16 v13, v112, v112
v_dot2c_f32_bf16 v12, v113, v14
v_dot2c_f32_bf16 v13, v113, v113
v_dot2c_f32_bf16 v12, v114, v14
v_dot2c_f32_bf16 v13, v114, v114
v_dot2c_f32_bf16 v12, v115, v14
v_dot2c_f32_bf16 v13, v115, v115
s_mov_b64 exec, -1
Lw_22:
s_nop 0
v_add_f32_dpp v12, v12, v12 row_ror:4 row_mask:0xf bank_mask:0xf
v_add_f32_dpp v13, v13, v13 row_ror:4 row_mask:0xf bank_mask:0xf
s_nop 0
v_add_f32_dpp v12, v12, v12 row_ror:8 row_mask:0xf bank_mask:0xf
v_add_f32_dpp v13, v13, v13 row_ror:8 row_mask:0xf bank_mask:0xf
s_mov_b64 exec, s[96:97]
ds_write_b64 v5, v[12:13]
s_mov_b64 exec, -1
s_waitcnt lgkmcnt(0)
s_barrier
Lnq0_21:
s_add_u32 s55, s54, 524288
buffer_load_dwordx4 a[128:131], v6, s[4:7], s55 offen offset:0 nt
buffer_load_dwordx4 a[132:135], v6, s[4:7], s55 offen offset:64 nt
buffer_load_dwordx4 a[136:139], v6, s[4:7], s55 offen offset:128 nt
buffer_load_dwordx4 a[140:143], v6, s[4:7], s55 offen offset:192 nt
s_cmp_lt_u32 s49, 16
s_cbranch_scc0 Lnq0_23
v_lshlrev_b32 v10, 3, v0
v_add_u32 v10, 152064, v10
ds_read_b64 v[10:11], v10
s_bfe_u32 s55, s49, 0x10003
s_mul_i32 s55, s55, 2304
v_bfe_u32 v5, v0, 2, 1
v_lshl_add_u32 v5, v5, 8, v3
v_add_u32 v5, s55, v5
ds_read_b128 v[108:111], v5 offset:0
ds_read_b128 v[112:115], v5 offset:512
ds_read_b128 v[12:15], v5 offset:1024
s_waitcnt lgkmcnt(2)
v_mfma_f32_16x16x32_bf16 v[120:123], v[72:75], v[108:111], 0
v_add_f32_dpp v10, v10, v10 row_ror:4 row_mask:0xf bank_mask:0xf
v_add_f32_dpp v11, v11, v11 row_ror:4 row_mask:0xf bank_mask:0xf
s_nop 0
v_add_f32_dpp v10, v10, v10 row_ror:8 row_mask:0xf bank_mask:0xf
v_add_f32_dpp v11, v11, v11 row_ror:8 row_mask:0xf bank_mask:0xf
v_mfma_f32_16x16x32_bf16 v[124:127], v[76:79], v[108:111], 0
s_nop 0
v_permlane32_swap_b32 v10, v11
v_add_f32 v10, v10, v11
v_mov_b32 v11, v10
ds_read_b128 v[108:111], v5 offset:1536
s_waitcnt lgkmcnt(2)
v_mfma_f32_16x16x32_bf16 v[120:123], v[80:83], v[112:115], v[120:123]
v_permlane16_swap_b32 v10, v11
v_add_f32 v10, v10, v11
v_mov_b32 v11, v10
v_mfma_f32_16x16x32_bf16 v[124:127], v[84:87], v[112:115], v[124:127]
s_nop 0
v_permlane32_swap_b32 v10, v11
v_mul_f32 v10, 0x3ae38e39, v10
v_mul_f32 v11, 0x3ae38e39, v11
ds_read_b128 v[112:115], v5 offset:2048
s_waitcnt lgkmcnt(2)
v_mfma_f32_16x16x32_bf16 v[120:123], v[88:91], v[12:15], v[120:123]
v_fma_f32 v11, -v10, v10, v11
v_max_f32 v11, 0, v11
v_add_f32 v11, 0x3727c5ac, v11
v_mfma_f32_16x16x32_bf16 v[124:127], v[92:95], v[12:15], v[124:127]
v_rsq_f32 v11, v11
s_waitcnt lgkmcnt(1)
v_mfma_f32_16x16x32_bf16 v[120:123], v[96:99], v[108:111], v[120:123]
v_mfma_f32_16x16x32_bf16 v[124:127], v[100:103], v[108:111], v[124:127]
s_waitcnt lgkmcnt(0)
v_mfma_f32_16x16x32_bf16 v[120:123], v[104:107], v[112:115], v[120:123]
s_nop 7
v_add_f32_dpp v120, v124, v120 row_shl:4 row_mask:0xf bank_mask:0xf
v_add_f32_dpp v121, v125, v121 row_shl:4 row_mask:0xf bank_mask:0xf
v_add_f32_dpp v122, v126, v122 row_shl:4 row_mask:0xf bank_mask:0xf
v_add_f32_dpp v123, v127, v123 row_shl:4 row_mask:0xf bank_mask:0xf
v_lshrrev_b32 v13, 4, v0
v_lshlrev_b32 v13, 6, v13
v_and_b32 v15, 3, v0
v_lshl_add_u32 v13, v15, 4, v13
v_fma_f32 v120, -v10, v116, v120
v_fma_f32 v121, -v10, v117, v121
v_fma_f32 v122, -v10, v118, v122
v_fma_f32 v123, -v10, v119, v123
v_mul_f32 v120, v11, v120
v_mul_f32 v121, v11, v121
v_mul_f32 v122, v11, v122
v_mul_f32 v123, v11, v123
s_mov_b64 exec, s[96:97]
buffer_store_dwordx4 v[120:123], v13, s[40:43], s71 offen sc1
s_mov_b64 exec, -1
Lnq0_23:
s_add_u32 s55, s54, 393216
s_add_u32 m0, s70, 24576
s_nop 0
buffer_load_dwordx4 v7, s[8:11], s55 offen offset:0 nt lds
buffer_load_dwordx4 v8, s[8:11], s55 offen offset:1024 nt lds
buffer_load_dwordx4 v7, s[8:11], s55 offen offset:2048 nt lds
buffer_load_dwordx4 v8, s[8:11], s55 offen offset:3072 nt lds
s_add_u32 s55, s54, 589824
buffer_load_dwordx4 a[144:147], v6, s[4:7], s55 offen offset:0 nt
buffer_load_dwordx4 a[148:151], v6, s[4:7], s55 offen offset:64 nt
buffer_load_dwordx4 a[152:155], v6, s[4:7], s55 offen offset:128 nt
buffer_load_dwordx4 a[156:159], v6, s[4:7], s55 offen offset:192 nt
s_waitcnt vmcnt(28)
ds_read_b64_tr_b16 v[160:161], v2 offset:8192
ds_read_b64_tr_b16 v[162:163], v2 offset:12288
v_xor_b32 v15, 32, v2
ds_read_b64_tr_b16 v[164:165], v15 offset:8192
ds_read_b64_tr_b16 v[166:167], v15 offset:12288
v_xor_b32 v15, 64, v2
ds_read_b64_tr_b16 v[168:169], v15 offset:8192
ds_read_b64_tr_b16 v[170:171], v15 offset:12288
v_xor_b32 v15, 96, v2
ds_read_b64_tr_b16 v[172:173], v15 offset:8192
ds_read_b64_tr_b16 v[174:175], v15 offset:12288
v_xor_b32 v15, 128, v2
ds_read_b64_tr_b16 v[176:177], v15 offset:8192
ds_read_b64_tr_b16 v[178:179], v15 offset:12288
v_xor_b32 v15, 160, v2
ds_read_b64_tr_b16 v[180:181], v15 offset:8192
ds_read_b64_tr_b16 v[182:183], v15 offset:12288
v_xor_b32 v15, 192, v2
ds_read_b64_tr_b16 v[184:185], v15 offset:8192
ds_read_b64_tr_b16 v[186:187], v15 offset:12288
v_xor_b32 v15, 224, v2
ds_read_b64_tr_b16 v[188:189], v15 offset:8192
ds_read_b64_tr_b16 v[190:191], v15 offset:12288
s_waitcnt lgkmcnt(0)
s_add_u32 s55, s54, 458752
s_add_u32 m0, s70, 28672
s_nop 0
buffer_load_dwordx4 v7, s[8:11], s55 offen offset:0 nt lds
buffer_load_dwordx4 v8, s[8:11], s55 offen offset:1024 nt lds
buffer_load_dwordx4 v7, s[8:11], s55 offen offset:2048 nt lds
buffer_load_dwordx4 v8, s[8:11], s55 offen offset:3072 nt lds
s_add_u32 s55, s54, 655360
buffer_load_dwordx4 a[160:163], v6, s[4:7], s55 offen offset:0 nt
buffer_load_dwordx4 a[164:167], v6, s[4:7], s55 offen offset:64 nt
buffer_load_dwordx4 a[168:171], v6, s[4:7], s55 offen offset:128 nt
buffer_load_dwordx4 a[172:175], v6, s[4:7], s55 offen offset:192 nt
s_add_u32 s55, s54, 524288
s_add_u32 m0, s70, 0
s_nop 0
buffer_load_dwordx4 v7, s[8:11], s55 offen offset:0 nt lds
buffer_load_dwordx4 v8, s[8:11], s55 offen offset:1024 nt lds
buffer_load_dwordx4 v7, s[8:11], s55 offen offset:2048 nt lds
buffer_load_dwordx4 v8, s[8:11], s55 offen offset:3072 nt lds
s_waitcnt vmcnt(24)
ds_read_b64_tr_b16 v[192:193], v2 offset:16384
ds_read_b64_tr_b16 v[194:195], v2 offset:20480
v_xor_b32 v15, 32, v2
ds_read_b64_tr_b16 v[196:197], v15 offset:16384
ds_read_b64_tr_b16 v[198:199], v15 offset:20480
v_xor_b32 v15, 64, v2
ds_read_b64_tr_b16 v[200:201], v15 offset:16384
ds_read_b64_tr_b16 v[202:203], v15 offset:20480
v_xor_b32 v15, 96, v2
ds_read_b64_tr_b16 v[204:205], v15 offset:16384
ds_read_b64_tr_b16 v[206:207], v15 offset:20480
v_xor_b32 v15, 128, v2
ds_read_b64_tr_b16 v[208:209], v15 offset:16384
ds_read_b64_tr_b16 v[210:211], v15 offset:20480
v_xor_b32 v15, 160, v2
ds_read_b64_tr_b16 v[212:213], v15 offset:16384
ds_read_b64_tr_b16 v[214:215], v15 offset:20480
v_xor_b32 v15, 192, v2
ds_read_b64_tr_b16 v[216:217], v15 offset:16384
ds_read_b64_tr_b16 v[218:219], v15 offset:20480
v_xor_b32 v15, 224, v2
ds_read_b64_tr_b16 v[220:221], v15 offset:16384
ds_read_b64_tr_b16 v[222:223], v15 offset:20480
s_waitcnt lgkmcnt(0)
s_add_u32 s55, s54, 720896
buffer_load_dwordx4 a[176:179], v6, s[4:7], s55 offen offset:0 nt
buffer_load_dwordx4 a[180:183], v6, s[4:7], s55 offen offset:64 nt
buffer_load_dwordx4 a[184:187], v6, s[4:7], s55 offen offset:128 nt
buffer_load_dwordx4 a[188:191], v6, s[4:7], s55 offen offset:192 nt
v_lshlrev_b32 v14, 5, v0
s_mov_b64 exec, 0xff
buffer_load_dwordx2 v[12:13], v14, s[44:47], 0 offen sc1
s_mov_b64 exec, -1
s_add_u32 s55, s54, 589824
s_add_u32 m0, s70, 4096
s_nop 0
buffer_load_dwordx4 v7, s[8:11], s55 offen offset:0 nt lds
buffer_load_dwordx4 v8, s[8:11], s55 offen offset:1024 nt lds
buffer_load_dwordx4 v7, s[8:11], s55 offen offset:2048 nt lds
buffer_load_dwordx4 v8, s[8:11], s55 offen offset:3072 nt lds
s_waitcnt vmcnt(17)
ds_read_b64_tr_b16 v[224:225], v2 offset:24576
ds_read_b64_tr_b16 v[226:227], v2 offset:28672
v_xor_b32 v15, 32, v2
ds_read_b64_tr_b16 v[228:229], v15 offset:24576
ds_read_b64_tr_b16 v[230:231], v15 offset:28672
v_xor_b32 v15, 64, v2
ds_read_b64_tr_b16 v[232:233], v15 offset:24576
ds_read_b64_tr_b16 v[234:235], v15 offset:28672
v_xor_b32 v15, 96, v2
ds_read_b64_tr_b16 v[236:237], v15 offset:24576
ds_read_b64_tr_b16 v[238:239], v15 offset:28672
v_xor_b32 v15, 128, v2
ds_read_b64_tr_b16 v[240:241], v15 offset:24576
ds_read_b64_tr_b16 v[242:243], v15 offset:28672
v_xor_b32 v15, 160, v2
ds_read_b64_tr_b16 v[244:245], v15 offset:24576
ds_read_b64_tr_b16 v[246:247], v15 offset:28672
v_xor_b32 v15, 192, v2
ds_read_b64_tr_b16 v[248:249], v15 offset:24576
ds_read_b64_tr_b16 v[250:251], v15 offset:28672
v_xor_b32 v15, 224, v2
ds_read_b64_tr_b16 v[252:253], v15 offset:24576
ds_read_b64_tr_b16 v[254:255], v15 offset:28672
s_waitcnt lgkmcnt(0)
s_add_u32 s55, s54, 786432
buffer_load_dwordx4 a[192:195], v6, s[4:7], s55 offen offset:0 nt
buffer_load_dwordx4 a[196:199], v6, s[4:7], s55 offen offset:64 nt
buffer_load_dwordx4 a[200:203], v6, s[4:7], s55 offen offset:128 nt
buffer_load_dwordx4 a[204:207], v6, s[4:7], s55 offen offset:192 nt
s_add_u32 s55, s54, 655360
s_add_u32 m0, s70, 8192
s_nop 0
buffer_load_dwordx4 v7, s[8:11], s55 offen offset:0 nt lds
buffer_load_dwordx4 v8, s[8:11], s55 offen offset:1024 nt lds
buffer_load_dwordx4 v7, s[8:11], s55 offen offset:2048 nt lds
buffer_load_dwordx4 v8, s[8:11], s55 offen offset:3072 nt lds
s_waitcnt vmcnt(12)
s_mov_b32 s52, 0
Lbp_24:
s_mov_b64 exec, 0xff
v_sad_u8 v11, v12, 0, 0
v_sad_u8 v11, v13, 0, v11
v_cmp_gt_u32 vcc, 32, v11
s_cbranch_vccz Lbd_25
s_sleep 8
v_lshlrev_b32 v14, 5, v0
buffer_load_dwordx2 v[12:13], v14, s[44:47], 0 offen sc1
s_waitcnt vmcnt(0)
s_add_u32 s52, s52, 1
s_cmp_lt_u32 s52, s51
s_cbranch_scc1 Lbp_24
s_mov_b32 s51, 0
Lbd_25:
s_mov_b64 exec, -1
v_readlane_b32 s58, v12, s48
v_readlane_b32 s59, v13, s48
s_bcnt1_i32_b64 s50, s[58:59]
s_cmp_eq_u32 s50, 1
s_cbranch_scc1 Lloc_26
v_mov_b32 v124, -1
v_mov_b32 v125, -1
v_mov_b32 v126, -1
v_mov_b32 v127, -1
s_mov_b32 exec_hi, 15
buffer_store_dwordx4 v[124:127], v1, s[40:43], s72 offen sc1
s_mov_b64 exec, 1
s_waitcnt vmcnt(0)
s_lshl_b32 s56, s48, 5
v_mov_b32 v14, s56
v_mov_b32 v11, 1
buffer_atomic_add v11, v14, s[44:47], 0 offen offset:8 sc1
s_mov_b32 s52, 0
Lb2_27:
s_sleep 8
buffer_load_dword v11, v14, s[44:47], 0 offen offset:8 sc1
s_waitcnt vmcnt(0)
v_cmp_gt_u32 vcc, 0x80, v11
s_cbranch_vccz Lloc_26
s_add_u32 s52, s52, 1
s_cmp_lt_u32 s52, s51
s_cbranch_scc1 Lb2_27
s_mov_b32 s51, 0
Lloc_26:
s_mov_b64 exec, -1
v_bfe_u32 v15, v0, 1, 2
v_lshrrev_b32 v10, 4, v0
v_lshl_add_u32 v15, v15, 2, v10
v_lshlrev_b32 v10, 7, v15
v_and_b32 v15, 1, v0
v_lshl_add_u32 v10, v15, 11, v10
v_bfe_u32 v15, v0, 3, 1
v_lshl_add_u32 v10, v15, 6, v10
s_cmp_lt_u32 s3, 2
s_cbranch_scc0 Lw_28
buffer_load_dwordx4 v[76:79], v10, s[40:43], s99 offen sc1
Lw_28:
s_mov_b32 exec_hi, 15
buffer_load_dwordx4 v[124:127], v1, s[40:43], s72 offen sc1
s_mov_b64 exec, -1
s_add_u32 s55, s54, 851968
buffer_load_dwordx4 a[208:211], v6, s[4:7], s55 offen offset:0 nt
buffer_load_dwordx4 a[212:215], v6, s[4:7], s55 offen offset:64 nt
buffer_load_dwordx4 a[216:219], v6, s[4:7], s55 offen offset:128 nt
buffer_load_dwordx4 a[220:223], v6, s[4:7], s55 offen offset:192 nt
s_add_u32 s55, s54, 720896
s_add_u32 m0, s70, 12288
s_nop 0
buffer_load_dwordx4 v7, s[8:11], s55 offen offset:0 nt lds
buffer_load_dwordx4 v8, s[8:11], s55 offen offset:1024 nt lds
buffer_load_dwordx4 v7, s[8:11], s55 offen offset:2048 nt lds
buffer_load_dwordx4 v8, s[8:11], s55 offen offset:3072 nt lds
s_waitcnt vmcnt(17)
ds_read_b64_tr_b16 v[80:81], v2 offset:0
ds_read_b64_tr_b16 v[82:83], v2 offset:4096
v_xor_b32 v15, 32, v2
ds_read_b64_tr_b16 v[84:85], v15 offset:0
ds_read_b64_tr_b16 v[86:87], v15 offset:4096
v_xor_b32 v15, 64, v2
ds_read_b64_tr_b16 v[88:89], v15 offset:0
ds_read_b64_tr_b16 v[90:91], v15 offset:4096
v_xor_b32 v15, 96, v2
ds_read_b64_tr_b16 v[92:93], v15 offset:0
ds_read_b64_tr_b16 v[94:95], v15 offset:4096
v_xor_b32 v15, 128, v2
ds_read_b64_tr_b16 v[96:97], v15 offset:0
ds_read_b64_tr_b16 v[98:99], v15 offset:4096
v_xor_b32 v15, 160, v2
ds_read_b64_tr_b16 v[100:101], v15 offset:0
ds_read_b64_tr_b16 v[102:103], v15 offset:4096
v_xor_b32 v15, 192, v2
ds_read_b64_tr_b16 v[104:105], v15 offset:0
ds_read_b64_tr_b16 v[106:107], v15 offset:4096
v_xor_b32 v15, 224, v2
ds_read_b64_tr_b16 v[108:109], v15 offset:0
ds_read_b64_tr_b16 v[110:111], v15 offset:4096
v_add_u32 v15, s70, v1
s_waitcnt lgkmcnt(0)
ds_write_b128 v15, v[80:83] offset:0
ds_write_b128 v15, v[84:87] offset:1024
ds_write_b128 v15, v[88:91] offset:2048
ds_write_b128 v15, v[92:95] offset:3072
ds_write_b128 v15, v[96:99] offset:4096
ds_write_b128 v15, v[100:103] offset:5120
ds_write_b128 v15, v[104:107] offset:6144
ds_write_b128 v15, v[108:111] offset:7168
s_add_u32 s55, s54, 917504
buffer_load_dwordx4 a[224:227], v6, s[4:7], s55 offen offset:0 nt
buffer_load_dwordx4 a[228:231], v6, s[4:7], s55 offen offset:64 nt
buffer_load_dwordx4 a[232:235], v6, s[4:7], s55 offen offset:128 nt
buffer_load_dwordx4 a[236:239], v6, s[4:7], s55 offen offset:192 nt
s_add_u32 s55, s54, 786432
s_add_u32 m0, s70, 16384
s_nop 0
buffer_load_dwordx4 v7, s[8:11], s55 offen offset:0 nt lds
buffer_load_dwordx4 v8, s[8:11], s55 offen offset:1024 nt lds
buffer_load_dwordx4 v7, s[8:11], s55 offen offset:2048 nt lds
buffer_load_dwordx4 v8, s[8:11], s55 offen offset:3072 nt lds
s_waitcnt vmcnt(8)
s_waitcnt lgkmcnt(0)
ds_read_b64_tr_b16 v[80:81], v2 offset:8192
ds_read_b64_tr_b16 v[82:83], v2 offset:12288
v_xor_b32 v15, 32, v2
ds_read_b64_tr_b16 v[84:85], v15 offset:8192
ds_read_b64_tr_b16 v[86:87], v15 offset:12288
v_xor_b32 v15, 64, v2
ds_read_b64_tr_b16 v[88:89], v15 offset:8192
ds_read_b64_tr_b16 v[90:91], v15 offset:12288
v_xor_b32 v15, 96, v2
ds_read_b64_tr_b16 v[92:93], v15 offset:8192
ds_read_b64_tr_b16 v[94:95], v15 offset:12288
v_xor_b32 v15, 128, v2
ds_read_b64_tr_b16 v[96:97], v15 offset:8192
ds_read_b64_tr_b16 v[98:99], v15 offset:12288
v_xor_b32 v15, 160, v2
ds_read_b64_tr_b16 v[100:101], v15 offset:8192
ds_read_b64_tr_b16 v[102:103], v15 offset:12288
v_xor_b32 v15, 192, v2
ds_read_b64_tr_b16 v[104:105], v15 offset:8192
ds_read_b64_tr_b16 v[106:107], v15 offset:12288
v_xor_b32 v15, 224, v2
ds_read_b64_tr_b16 v[108:109], v15 offset:8192
ds_read_b64_tr_b16 v[110:111], v15 offset:12288
v_add_u32 v15, s70, v1
s_waitcnt lgkmcnt(0)
ds_write_b128 v15, v[80:83] offset:8192
ds_write_b128 v15, v[84:87] offset:9216
ds_write_b128 v15, v[88:91] offset:10240
ds_write_b128 v15, v[92:95] offset:11264
ds_write_b128 v15, v[96:99] offset:12288
ds_write_b128 v15, v[100:103] offset:13312
ds_write_b128 v15, v[104:107] offset:14336
ds_write_b128 v15, v[108:111] offset:15360
s_cmp_lt_u32 s3, 2
s_cbranch_scc0 Lw_29
s_mov_b32 s52, -1
v_cmp_eq_u32 vcc, -1, v76
s_cbranch_vccz Lqok_30
s_mov_b32 s52, 0
Lpoll_31:
buffer_load_dwordx4 v[76:79], v10, s[40:43], s99 offen sc1
s_waitcnt vmcnt(0)
v_cmp_eq_u32 vcc, -1, v76
s_cbranch_vccnz Lpretry_32
Lpdone_33:
Lqok_30:
ds_write_b128 v4, v[76:79]
s_waitcnt lgkmcnt(0)
Lw_29:
s_waitcnt lgkmcnt(0)
s_barrier
v_add_u32 v10, 155648, v1
ds_read_b128 v[76:79], v10
ds_read_b128 v[80:83], v10 offset:2048
s_waitcnt lgkmcnt(0)
v_add_f32 v76, v76, v80
v_add_f32 v77, v77, v81
v_add_f32 v78, v78, v82
v_add_f32 v79, v79, v83
v_mov_b32_dpp v80, v76 row_shl:8 row_mask:0xf bank_mask:0xf
v_mov_b32_dpp v81, v77 row_shl:8 row_mask:0xf bank_mask:0xf
v_mov_b32_dpp v82, v78 row_shl:8 row_mask:0xf bank_mask:0xf
v_mov_b32_dpp v83, v79 row_shl:8 row_mask:0xf bank_mask:0xf
v_cvt_pk_bf16_f32 v88, v76, v77
v_cvt_pk_bf16_f32 v89, v78, v79
v_cvt_pk_bf16_f32 v90, v80, v81
v_cvt_pk_bf16_f32 v91, v82, v83
v_mov_b32 v72, 0
v_mov_b32 v73, 0
v_mov_b32 v74, 0
v_mov_b32 v75, 0
v_mov_b32 v76, 0
v_mov_b32 v77, 0
v_mov_b32 v78, 0
v_mov_b32 v79, 0
v_mov_b32 v80, 0
v_mov_b32 v81, 0
v_mov_b32 v82, 0
v_mov_b32 v83, 0
v_mov_b32 v84, 0
v_mov_b32 v85, 0
v_mov_b32 v86, 0
v_mov_b32 v87, 0
v_mov_b32_dpp v72, v88 quad_perm:[0,1,2,3] row_mask:0xf bank_mask:0x1
v_mov_b32_dpp v73, v89 quad_perm:[0,1,2,3] row_mask:0xf bank_mask:0x1
v_mov_b32_dpp v74, v90 quad_perm:[0,1,2,3] row_mask:0xf bank_mask:0x1
v_mov_b32_dpp v75, v91 quad_perm:[0,1,2,3] row_mask:0xf bank_mask:0x1
v_mov_b32_dpp v76, v88 row_shl:2 row_mask:0xf bank_mask:0x1
v_mov_b32_dpp v77, v89 row_shl:2 row_mask:0xf bank_mask:0x1
v_mov_b32_dpp v78, v90 row_shl:2 row_mask:0xf bank_mask:0x1
v_mov_b32_dpp v79, v91 row_shl:2 row_mask:0xf bank_mask:0x1
v_mov_b32_dpp v80, v88 row_shl:4 row_mask:0xf bank_mask:0x1
v_mov_b32_dpp v81, v89 row_shl:4 row_mask:0xf bank_mask:0x1
v_mov_b32_dpp v82, v90 row_shl:4 row_mask:0xf bank_mask:0x1
v_mov_b32_dpp v83, v91 row_shl:4 row_mask:0xf bank_mask:0x1
v_mov_b32_dpp v84, v88 row_shl:6 row_mask:0xf bank_mask:0x1
v_mov_b32_dpp v85, v89 row_shl:6 row_mask:0xf bank_mask:0x1
v_mov_b32_dpp v86, v90 row_shl:6 row_mask:0xf bank_mask:0x1
v_mov_b32_dpp v87, v91 row_shl:6 row_mask:0xf bank_mask:0x1
v_mfma_f32_16x16x32_bf16 v[88:91], a[0:3], v[72:75], 0
v_mfma_f32_16x16x32_bf16 v[88:91], a[4:7], v[76:79], v[88:91]
v_mfma_f32_16x16x32_bf16 v[88:91], a[8:11], v[80:83], v[88:91]
v_mfma_f32_16x16x32_bf16 v[88:91], a[12:15], v[84:87], v[88:91]
v_mfma_f32_16x16x32_bf16 v[92:95], a[16:19], v[72:75], 0
v_mfma_f32_16x16x32_bf16 v[92:95], a[20:23], v[76:79], v[92:95]
v_mfma_f32_16x16x32_bf16 v[92:95], a[24:27], v[80:83], v[92:95]
v_mfma_f32_16x16x32_bf16 v[92:95], a[28:31], v[84:87], v[92:95]
v_mfma_f32_16x16x32_bf16 v[96:99], a[32:35], v[72:75], 0
s_nop 2
v_mov_b32 v100, v88
v_mfma_f32_16x16x32_bf16 v[96:99], a[36:39], v[76:79], v[96:99]
v_mov_b32 v101, v89
v_mfma_f32_16x16x32_bf16 v[96:99], a[40:43], v[80:83], v[96:99]
v_mov_b32 v102, v90
v_mfma_f32_16x16x32_bf16 v[96:99], a[44:47], v[84:87], v[96:99]
v_mov_b32 v103, v91
v_mfma_f32_16x16x32_bf16 v[88:91], a[48:51], v[72:75], 0
v_mov_b32_dpp v100, v92 row_shr:2 row_mask:0xf bank_mask:0xf
v_mfma_f32_16x16x32_bf16 v[88:91], a[52:55], v[76:79], v[88:91]
v_mov_b32_dpp v101, v93 row_shr:2 row_mask:0xf bank_mask:0xf
v_mfma_f32_16x16x32_bf16 v[88:91], a[56:59], v[80:83], v[88:91]
v_mov_b32_dpp v102, v94 row_shr:2 row_mask:0xf bank_mask:0xf
v_mfma_f32_16x16x32_bf16 v[88:91], a[60:63], v[84:87], v[88:91]
v_mov_b32_dpp v103, v95 row_shr:2 row_mask:0xf bank_mask:0xf
v_mfma_f32_16x16x32_bf16 v[92:95], a[64:67], v[72:75], 0
v_mov_b32_dpp v100, v96 row_shr:4 row_mask:0xf bank_mask:0xf
v_mfma_f32_16x16x32_bf16 v[92:95], a[68:71], v[76:79], v[92:95]
v_mov_b32_dpp v101, v97 row_shr:4 row_mask:0xf bank_mask:0xf
v_mfma_f32_16x16x32_bf16 v[92:95], a[72:75], v[80:83], v[92:95]
v_mov_b32_dpp v102, v98 row_shr:4 row_mask:0xf bank_mask:0xf
v_mfma_f32_16x16x32_bf16 v[92:95], a[76:79], v[84:87], v[92:95]
v_mov_b32_dpp v103, v99 row_shr:4 row_mask:0xf bank_mask:0xf
v_mfma_f32_16x16x32_bf16 v[96:99], a[80:83], v[72:75], 0
v_mov_b32_dpp v100, v88 row_shr:6 row_mask:0xf bank_mask:0xf
v_mfma_f32_16x16x32_bf16 v[96:99], a[84:87], v[76:79], v[96:99]
v_mov_b32_dpp v101, v89 row_shr:6 row_mask:0xf bank_mask:0xf
v_mfma_f32_16x16x32_bf16 v[96:99], a[88:91], v[80:83], v[96:99]
v_mov_b32_dpp v102, v90 row_shr:6 row_mask:0xf bank_mask:0xf
v_mfma_f32_16x16x32_bf16 v[96:99], a[92:95], v[84:87], v[96:99]
v_mov_b32_dpp v103, v91 row_shr:6 row_mask:0xf bank_mask:0xf
s_add_u32 s55, s54, 983040
s_lshl_b32 s56, s3, 12
s_add_u32 m0, s56, 131072
s_nop 0
buffer_load_dwordx4 v6, s[4:7], s55 offen offset:0 nt lds
s_lshl_b32 s56, s3, 12
s_add_u32 m0, s56, 132032
s_nop 0
buffer_load_dwordx4 v6, s[4:7], s55 offen offset:64 nt lds
s_lshl_b32 s56, s3, 12
s_add_u32 m0, s56, 132992
s_nop 0
buffer_load_dwordx4 v6, s[4:7], s55 offen offset:128 nt lds
s_lshl_b32 s56, s3, 12
s_add_u32 m0, s56, 133952
s_nop 0
buffer_load_dwordx4 v6, s[4:7], s55 offen offset:192 nt lds
s_add_u32 s55, s54, 851968
s_add_u32 m0, s70, 20480
s_nop 0
buffer_load_dwordx4 v7, s[8:11], s55 offen offset:0 nt lds
buffer_load_dwordx4 v8, s[8:11], s55 offen offset:1024 nt lds
buffer_load_dwordx4 v7, s[8:11], s55 offen offset:2048 nt lds
buffer_load_dwordx4 v8, s[8:11], s55 offen offset:3072 nt lds
v_mfma_f32_16x16x32_bf16 v[88:91], a[96:99], v[72:75], 0
v_mov_b32_dpp v100, v92 row_shr:8 row_mask:0xf bank_mask:0xf
v_mfma_f32_16x16x32_bf16 v[88:91], a[100:103], v[76:79], v[88:91]
v_mov_b32_dpp v101, v93 row_shr:8 row_mask:0xf bank_mask:0xf
v_mfma_f32_16x16x32_bf16 v[88:91], a[104:107], v[80:83], v[88:91]
v_mov_b32_dpp v102, v94 row_shr:8 row_mask:0xf bank_mask:0xf
v_mfma_f32_16x16x32_bf16 v[88:91], a[108:111], v[84:87], v[88:91]
v_mov_b32_dpp v103, v95 row_shr:8 row_mask:0xf bank_mask:0xf
v_mfma_f32_16x16x32_bf16 v[92:95], a[112:115], v[72:75], 0
v_mov_b32_dpp v100, v96 row_shr:10 row_mask:0xf bank_mask:0xf
v_mfma_f32_16x16x32_bf16 v[92:95], a[116:119], v[76:79], v[92:95]
v_mov_b32_dpp v101, v97 row_shr:10 row_mask:0xf bank_mask:0xf
v_mfma_f32_16x16x32_bf16 v[92:95], a[120:123], v[80:83], v[92:95]
v_mov_b32_dpp v102, v98 row_shr:10 row_mask:0xf bank_mask:0xf
v_mfma_f32_16x16x32_bf16 v[92:95], a[124:127], v[84:87], v[92:95]
v_mov_b32_dpp v103, v99 row_shr:10 row_mask:0xf bank_mask:0xf
v_mfma_f32_16x16x32_bf16 v[96:99], a[128:131], v[72:75], 0
v_mov_b32_dpp v100, v88 row_shr:12 row_mask:0xf bank_mask:0xf
v_mfma_f32_16x16x32_bf16 v[96:99], a[132:135], v[76:79], v[96:99]
v_mov_b32_dpp v101, v89 row_shr:12 row_mask:0xf bank_mask:0xf
v_mfma_f32_16x16x32_bf16 v[96:99], a[136:139], v[80:83], v[96:99]
v_mov_b32_dpp v102, v90 row_shr:12 row_mask:0xf bank_mask:0xf
v_mfma_f32_16x16x32_bf16 v[96:99], a[140:143], v[84:87], v[96:99]
v_mov_b32_dpp v103, v91 row_shr:12 row_mask:0xf bank_mask:0xf
v_mfma_f32_16x16x32_bf16 v[88:91], a[144:147], v[72:75], 0
v_mov_b32_dpp v100, v92 row_shr:14 row_mask:0xf bank_mask:0xf
v_mfma_f32_16x16x32_bf16 v[88:91], a[148:151], v[76:79], v[88:91]
v_mov_b32_dpp v101, v93 row_shr:14 row_mask:0xf bank_mask:0xf
v_mfma_f32_16x16x32_bf16 v[88:91], a[152:155], v[80:83], v[88:91]
v_mov_b32_dpp v102, v94 row_shr:14 row_mask:0xf bank_mask:0xf
v_mfma_f32_16x16x32_bf16 v[88:91], a[156:159], v[84:87], v[88:91]
v_mov_b32_dpp v103, v95 row_shr:14 row_mask:0xf bank_mask:0xf
v_mfma_f32_16x16x32_bf16 v[92:95], a[160:163], v[72:75], 0
v_mov_b32 v104, v96
v_mfma_f32_16x16x32_bf16 v[92:95], a[164:167], v[76:79], v[92:95]
v_mov_b32 v105, v97
v_mfma_f32_16x16x32_bf16 v[92:95], a[168:171], v[80:83], v[92:95]
v_mov_b32 v106, v98
v_mfma_f32_16x16x32_bf16 v[92:95], a[172:175], v[84:87], v[92:95]
v_mov_b32 v107, v99
v_mfma_f32_16x16x32_bf16 v[96:99], a[176:179], v[72:75], 0
v_mov_b32_dpp v104, v88 row_shr:2 row_mask:0xf bank_mask:0xf
v_mfma_f32_16x16x32_bf16 v[96:99], a[180:183], v[76:79], v[96:99]
v_mov_b32_dpp v105, v89 row_shr:2 row_mask:0xf bank_mask:0xf
v_mfma_f32_16x16x32_bf16 v[96:99], a[184:187], v[80:83], v[96:99]
v_mov_b32_dpp v106, v90 row_shr:2 row_mask:0xf bank_mask:0xf
v_mfma_f32_16x16x32_bf16 v[96:99], a[188:191], v[84:87], v[96:99]
v_mov_b32_dpp v107, v91 row_shr:2 row_mask:0xf bank_mask:0xf
s_add_u32 s55, s54, 917504
s_add_u32 m0, s70, 24576
s_nop 0
buffer_load_dwordx4 v7, s[8:11], s55 offen offset:0 nt lds
buffer_load_dwordx4 v8, s[8:11], s55 offen offset:1024 nt lds
buffer_load_dwordx4 v7, s[8:11], s55 offen offset:2048 nt lds
buffer_load_dwordx4 v8, s[8:11], s55 offen offset:3072 nt lds
s_add_u32 s55, s54, 983040
s_add_u32 m0, s70, 28672
s_nop 0
buffer_load_dwordx4 v7, s[8:11], s55 offen offset:0 nt lds
buffer_load_dwordx4 v8, s[8:11], s55 offen offset:1024 nt lds
buffer_load_dwordx4 v7, s[8:11], s55 offen offset:2048 nt lds
buffer_load_dwordx4 v8, s[8:11], s55 offen offset:3072 nt lds
v_mfma_f32_16x16x32_bf16 v[88:91], a[192:195], v[72:75], 0
v_mov_b32_dpp v104, v92 row_shr:4 row_mask:0xf bank_mask:0xf
v_mfma_f32_16x16x32_bf16 v[88:91], a[196:199], v[76:79], v[88:91]
v_mov_b32_dpp v105, v93 row_shr:4 row_mask:0xf bank_mask:0xf
v_mfma_f32_16x16x32_bf16 v[88:91], a[200:203], v[80:83], v[88:91]
v_mov_b32_dpp v106, v94 row_shr:4 row_mask:0xf bank_mask:0xf
v_mfma_f32_16x16x32_bf16 v[88:91], a[204:207], v[84:87], v[88:91]
v_mov_b32_dpp v107, v95 row_shr:4 row_mask:0xf bank_mask:0xf
s_waitcnt vmcnt(28)
v_mfma_f32_16x16x32_bf16 v[92:95], a[208:211], v[72:75], 0
v_mov_b32_dpp v104, v96 row_shr:6 row_mask:0xf bank_mask:0xf
v_mfma_f32_16x16x32_bf16 v[92:95], a[212:215], v[76:79], v[92:95]
v_mov_b32_dpp v105, v97 row_shr:6 row_mask:0xf bank_mask:0xf
v_mfma_f32_16x16x32_bf16 v[92:95], a[216:219], v[80:83], v[92:95]
v_mov_b32_dpp v106, v98 row_shr:6 row_mask:0xf bank_mask:0xf
v_mfma_f32_16x16x32_bf16 v[92:95], a[220:223], v[84:87], v[92:95]
v_mov_b32_dpp v107, v99 row_shr:6 row_mask:0xf bank_mask:0xf
s_waitcnt vmcnt(20)
v_mfma_f32_16x16x32_bf16 v[96:99], a[224:227], v[72:75], 0
v_mov_b32_dpp v104, v88 row_shr:8 row_mask:0xf bank_mask:0xf
v_mfma_f32_16x16x32_bf16 v[96:99], a[228:231], v[76:79], v[96:99]
v_mov_b32_dpp v105, v89 row_shr:8 row_mask:0xf bank_mask:0xf
v_mfma_f32_16x16x32_bf16 v[96:99], a[232:235], v[80:83], v[96:99]
v_mov_b32_dpp v106, v90 row_shr:8 row_mask:0xf bank_mask:0xf
v_mfma_f32_16x16x32_bf16 v[96:99], a[236:239], v[84:87], v[96:99]
v_mov_b32_dpp v107, v91 row_shr:8 row_mask:0xf bank_mask:0xf
s_waitcnt vmcnt(12)
s_lshl_b32 s56, s3, 12
s_add_u32 s56, s56, 131072
v_add_u32 v11, s56, v1
ds_read_b128 v[108:111], v11 offset:0
ds_read_b128 v[112:115], v11 offset:1024
ds_read_b128 v[116:119], v11 offset:2048
ds_read_b128 v[120:123], v11 offset:3072
s_waitcnt lgkmcnt(0)
v_mfma_f32_16x16x32_bf16 v[88:91], v[108:111], v[72:75], 0
v_mov_b32_dpp v104, v92 row_shr:10 row_mask:0xf bank_mask:0xf
v_mfma_f32_16x16x32_bf16 v[88:91], v[112:115], v[76:79], v[88:91]
v_mov_b32_dpp v105, v93 row_shr:10 row_mask:0xf bank_mask:0xf
v_mfma_f32_16x16x32_bf16 v[88:91], v[116:119], v[80:83], v[88:91]
v_mov_b32_dpp v106, v94 row_shr:10 row_mask:0xf bank_mask:0xf
v_mfma_f32_16x16x32_bf16 v[88:91], v[120:123], v[84:87], v[88:91]
v_mov_b32_dpp v107, v95 row_shr:10 row_mask:0xf bank_mask:0xf
v_mov_b32_dpp v104, v96 row_shr:12 row_mask:0xf bank_mask:0xf
v_mov_b32_dpp v105, v97 row_shr:12 row_mask:0xf bank_mask:0xf
v_mov_b32_dpp v106, v98 row_shr:12 row_mask:0xf bank_mask:0xf
v_mov_b32_dpp v107, v99 row_shr:12 row_mask:0xf bank_mask:0xf
v_add_u32 v10, s70, v1
ds_read_b128 v[112:115], v10 offset:0
ds_read_b128 v[116:119], v10 offset:1024
ds_read_b128 v[124:127], v10 offset:2048
ds_read_b128 v[12:15], v10 offset:3072
v_max3_f32 v11, v100, v101, v102
v_mov_b32_dpp v104, v88 row_shr:14 row_mask:0xf bank_mask:0xf
v_mov_b32_dpp v105, v89 row_shr:14 row_mask:0xf bank_mask:0xf
v_mov_b32_dpp v106, v90 row_shr:14 row_mask:0xf bank_mask:0xf
v_mov_b32_dpp v107, v91 row_shr:14 row_mask:0xf bank_mask:0xf
v_max3_f32 v88, v103, v104, v105
v_max3_f32 v11, v11, v106, v107
v_max_f32 v11, v11, v88
s_nop 1
v_max_f32_dpp v11, v11, v11 row_ror:2 row_mask:0xf bank_mask:0xf
s_nop 1
v_max_f32_dpp v11, v11, v11 row_ror:4 row_mask:0xf bank_mask:0xf
s_nop 1
v_max_f32_dpp v11, v11, v11 row_ror:8 row_mask:0xf bank_mask:0xf
v_mov_b32 v88, v11
s_nop 1
v_permlane16_swap_b32 v11, v88
v_max_f32 v11, v11, v88
v_mov_b32 v88, v11
s_nop 1
v_permlane32_swap_b32 v11, v88
v_max_f32 v11, v11, v88
v_mul_f32 v11, s60, v11
v_fma_f32 v100, v100, s60, -v11
v_fma_f32 v101, v101, s60, -v11
v_fma_f32 v102, v102, s60, -v11
v_fma_f32 v103, v103, s60, -v11
v_fma_f32 v104, v104, s60, -v11
v_fma_f32 v105, v105, s60, -v11
v_fma_f32 v106, v106, s60, -v11
v_fma_f32 v107, v107, s60, -v11
v_exp_f32 v100, v100
v_exp_f32 v101, v101
v_exp_f32 v102, v102
v_exp_f32 v103, v103
v_exp_f32 v104, v104
v_exp_f32 v105, v105
v_exp_f32 v106, v106
v_exp_f32 v107, v107
v_cvt_pk_bf16_f32 v120, v100, v101
v_cvt_pk_bf16_f32 v121, v102, v103
v_cvt_pk_bf16_f32 v122, v104, v105
v_cvt_pk_bf16_f32 v123, v106, v107
v_add_f32 v5, v104, v105
v_add_f32 v88, v106, v107
v_add_f32 v5, v5, v88
v_mov_b32 v104, 0
v_mov_b32 v105, 0
v_mov_b32 v106, 0
v_mov_b32 v107, 0
v_mov_b32 v108, 0
v_mov_b32 v109, 0
v_mov_b32 v110, 0
v_mov_b32 v111, 0
v_mov_b32_dpp v104, v120 quad_perm:[0,1,2,3] row_mask:0xf bank_mask:0x1 bound_ctrl:0
v_mov_b32_dpp v105, v121 quad_perm:[0,1,2,3] row_mask:0xf bank_mask:0x1 bound_ctrl:0
v_mov_b32_dpp v106, v120 row_shl:2 row_mask:0xf bank_mask:0x1 bound_ctrl:0
v_mov_b32_dpp v107, v121 row_shl:2 row_mask:0xf bank_mask:0x1 bound_ctrl:0
v_mov_b32_dpp v108, v122 quad_perm:[0,1,2,3] row_mask:0xf bank_mask:0x1 bound_ctrl:0
v_mov_b32_dpp v109, v123 quad_perm:[0,1,2,3] row_mask:0xf bank_mask:0x1 bound_ctrl:0
v_mov_b32_dpp v110, v122 row_shl:2 row_mask:0xf bank_mask:0x1 bound_ctrl:0
v_mov_b32_dpp v111, v123 row_shl:2 row_mask:0xf bank_mask:0x1 bound_ctrl:0
v_mfma_f32_16x16x32_bf16 v[72:75], v[128:131], v[104:107], 0
v_add_f32 v5, v5, v100
v_mfma_f32_16x16x32_bf16 v[76:79], v[132:135], v[104:107], 0
v_add_f32 v5, v5, v101
buffer_load_dwordx4 v[16:19], v9, s[20:23], s98 offen nt
v_mfma_f32_16x16x32_bf16 v[80:83], v[136:139], v[104:107], 0
v_add_f32 v5, v5, v102
v_mfma_f32_16x16x32_bf16 v[84:87], v[140:143], v[104:107], 0
v_add_f32 v5, v5, v103
s_waitcnt lgkmcnt(3)
v_mfma_f32_16x16x32_bf16 v[72:75], v[112:115], v[108:111], v[72:75]
ds_read_b128 v[112:115], v10 offset:4096
s_waitcnt lgkmcnt(3)
v_mfma_f32_16x16x32_bf16 v[76:79], v[116:119], v[108:111], v[76:79]
ds_read_b128 v[116:119], v10 offset:5120
s_waitcnt lgkmcnt(3)
v_mfma_f32_16x16x32_bf16 v[80:83], v[124:127], v[108:111], v[80:83]
ds_read_b128 v[124:127], v10 offset:6144
s_waitcnt lgkmcnt(3)
v_mfma_f32_16x16x32_bf16 v[84:87], v[12:15], v[108:111], v[84:87]
ds_read_b128 v[12:15], v10 offset:7168
s_add_u32 s98, s98, 73728
buffer_load_dwordx4 v[20:23], v9, s[20:23], s98 offen nt
v_mfma_f32_16x16x32_bf16 v[88:91], v[144:147], v[104:107], 0
v_mfma_f32_16x16x32_bf16 v[92:95], v[148:151], v[104:107], 0
v_mfma_f32_16x16x32_bf16 v[96:99], v[152:155], v[104:107], 0
v_mfma_f32_16x16x32_bf16 v[100:103], v[156:159], v[104:107], 0
v_mov_b32_dpp v104, v120 row_shl:4 row_mask:0xf bank_mask:0x1 bound_ctrl:0
s_waitcnt lgkmcnt(3)
v_mfma_f32_16x16x32_bf16 v[88:91], v[112:115], v[108:111], v[88:91]
ds_read_b128 v[112:115], v10 offset:8192
v_mov_b32_dpp v105, v121 row_shl:4 row_mask:0xf bank_mask:0x1 bound_ctrl:0
s_waitcnt lgkmcnt(3)
v_mfma_f32_16x16x32_bf16 v[92:95], v[116:119], v[108:111], v[92:95]
ds_read_b128 v[116:119], v10 offset:9216
v_mov_b32_dpp v106, v120 row_shl:6 row_mask:0xf bank_mask:0x1 bound_ctrl:0
s_add_u32 s98, s98, 516096
buffer_load_dwordx4 v[24:27], v9, s[20:23], s98 offen nt
s_waitcnt lgkmcnt(3)
v_mfma_f32_16x16x32_bf16 v[96:99], v[124:127], v[108:111], v[96:99]
ds_read_b128 v[124:127], v10 offset:10240
v_mov_b32_dpp v107, v121 row_shl:6 row_mask:0xf bank_mask:0x1 bound_ctrl:0
s_waitcnt lgkmcnt(3)
v_mfma_f32_16x16x32_bf16 v[100:103], v[12:15], v[108:111], v[100:103]
ds_read_b128 v[12:15], v10 offset:11264
v_mov_b32_dpp v108, v122 row_shl:4 row_mask:0xf bank_mask:0x1 bound_ctrl:0
v_mfma_f32_16x16x32_bf16 v[72:75], v[160:163], v[104:107], v[72:75]
v_mov_b32_dpp v109, v123 row_shl:4 row_mask:0xf bank_mask:0x1 bound_ctrl:0
v_mfma_f32_16x16x32_bf16 v[76:79], v[164:167], v[104:107], v[76:79]
v_mov_b32_dpp v110, v122 row_shl:6 row_mask:0xf bank_mask:0x1 bound_ctrl:0
v_mfma_f32_16x16x32_bf16 v[80:83], v[168:171], v[104:107], v[80:83]
v_mov_b32_dpp v111, v123 row_shl:6 row_mask:0xf bank_mask:0x1 bound_ctrl:0
v_mfma_f32_16x16x32_bf16 v[84:87], v[172:175], v[104:107], v[84:87]
s_add_u32 s98, s98, 73728
buffer_load_dwordx4 v[28:31], v9, s[20:23], s98 offen nt
s_waitcnt lgkmcnt(3)
v_mfma_f32_16x16x32_bf16 v[72:75], v[112:115], v[108:111], v[72:75]
ds_read_b128 v[112:115], v10 offset:12288
s_waitcnt lgkmcnt(3)
v_mfma_f32_16x16x32_bf16 v[76:79], v[116:119], v[108:111], v[76:79]
ds_read_b128 v[116:119], v10 offset:13312
s_waitcnt lgkmcnt(3)
v_mfma_f32_16x16x32_bf16 v[80:83], v[124:127], v[108:111], v[80:83]
ds_read_b128 v[124:127], v10 offset:14336
s_waitcnt lgkmcnt(3)
v_mfma_f32_16x16x32_bf16 v[84:87], v[12:15], v[108:111], v[84:87]
ds_read_b128 v[12:15], v10 offset:15360
v_mfma_f32_16x16x32_bf16 v[88:91], v[176:179], v[104:107], v[88:91]
v_mfma_f32_16x16x32_bf16 v[92:95], v[180:183], v[104:107], v[92:95]
s_add_u32 s98, s98, 516096
buffer_load_dwordx4 v[32:35], v9, s[20:23], s98 offen nt
v_mfma_f32_16x16x32_bf16 v[96:99], v[184:187], v[104:107], v[96:99]
v_mfma_f32_16x16x32_bf16 v[100:103], v[188:191], v[104:107], v[100:103]
v_mov_b32_dpp v104, v120 row_shl:8 row_mask:0xf bank_mask:0x1 bound_ctrl:0
s_waitcnt vmcnt(13)
s_waitcnt lgkmcnt(3)
v_mfma_f32_16x16x32_bf16 v[88:91], v[112:115], v[108:111], v[88:91]
ds_read_b64_tr_b16 v[112:113], v2 offset:16384
ds_read_b64_tr_b16 v[114:115], v2 offset:20480
v_mov_b32_dpp v105, v121 row_shl:8 row_mask:0xf bank_mask:0x1 bound_ctrl:0
s_waitcnt lgkmcnt(4)
v_mfma_f32_16x16x32_bf16 v[92:95], v[116:119], v[108:111], v[92:95]
v_xor_b32 v10, 32, v2
ds_read_b64_tr_b16 v[116:117], v10 offset:16384
ds_read_b64_tr_b16 v[118:119], v10 offset:20480
v_mov_b32_dpp v106, v120 row_shl:10 row_mask:0xf bank_mask:0x1 bound_ctrl:0
s_waitcnt lgkmcnt(5)
v_mfma_f32_16x16x32_bf16 v[96:99], v[124:127], v[108:111], v[96:99]
v_xor_b32 v10, 64, v2
ds_read_b64_tr_b16 v[124:125], v10 offset:16384
ds_read_b64_tr_b16 v[126:127], v10 offset:20480
v_mov_b32_dpp v107, v121 row_shl:10 row_mask:0xf bank_mask:0x1 bound_ctrl:0
s_waitcnt lgkmcnt(6)
v_mfma_f32_16x16x32_bf16 v[100:103], v[12:15], v[108:111], v[100:103]
v_xor_b32 v10, 96, v2
ds_read_b64_tr_b16 v[12:13], v10 offset:16384
ds_read_b64_tr_b16 v[14:15], v10 offset:20480
v_mov_b32_dpp v108, v122 row_shl:8 row_mask:0xf bank_mask:0x1 bound_ctrl:0
s_add_u32 s98, s98, 73728
buffer_load_dwordx4 v[36:39], v9, s[20:23], s98 offen nt
v_mfma_f32_16x16x32_bf16 v[72:75], v[192:195], v[104:107], v[72:75]
v_mov_b32_dpp v109, v123 row_shl:8 row_mask:0xf bank_mask:0x1 bound_ctrl:0
v_mfma_f32_16x16x32_bf16 v[76:79], v[196:199], v[104:107], v[76:79]
v_mov_b32_dpp v110, v122 row_shl:10 row_mask:0xf bank_mask:0x1 bound_ctrl:0
v_mfma_f32_16x16x32_bf16 v[80:83], v[200:203], v[104:107], v[80:83]
v_mov_b32_dpp v111, v123 row_shl:10 row_mask:0xf bank_mask:0x1 bound_ctrl:0
v_mfma_f32_16x16x32_bf16 v[84:87], v[204:207], v[104:107], v[84:87]
s_waitcnt lgkmcnt(6)
v_mfma_f32_16x16x32_bf16 v[72:75], v[112:115], v[108:111], v[72:75]
v_xor_b32 v10, 128, v2
ds_read_b64_tr_b16 v[112:113], v10 offset:16384
ds_read_b64_tr_b16 v[114:115], v10 offset:20480
s_waitcnt lgkmcnt(6)
v_mfma_f32_16x16x32_bf16 v[76:79], v[116:119], v[108:111], v[76:79]
v_xor_b32 v10, 160, v2
ds_read_b64_tr_b16 v[116:117], v10 offset:16384
ds_read_b64_tr_b16 v[118:119], v10 offset:20480
s_add_u32 s98, s98, 516096
buffer_load_dwordx4 v[40:43], v9, s[20:23], s98 offen nt
s_waitcnt lgkmcnt(6)
v_mfma_f32_16x16x32_bf16 v[80:83], v[124:127], v[108:111], v[80:83]
v_xor_b32 v10, 192, v2
ds_read_b64_tr_b16 v[124:125], v10 offset:16384
ds_read_b64_tr_b16 v[126:127], v10 offset:20480
s_waitcnt lgkmcnt(6)
v_mfma_f32_16x16x32_bf16 v[84:87], v[12:15], v[108:111], v[84:87]
v_xor_b32 v10, 224, v2
ds_read_b64_tr_b16 v[12:13], v10 offset:16384
ds_read_b64_tr_b16 v[14:15], v10 offset:20480
v_mfma_f32_16x16x32_bf16 v[88:91], v[208:211], v[104:107], v[88:91]
v_mfma_f32_16x16x32_bf16 v[92:95], v[212:215], v[104:107], v[92:95]
v_mfma_f32_16x16x32_bf16 v[96:99], v[216:219], v[104:107], v[96:99]
v_mfma_f32_16x16x32_bf16 v[100:103], v[220:223], v[104:107], v[100:103]
v_mov_b32_dpp v104, v120 row_shl:12 row_mask:0xf bank_mask:0x1 bound_ctrl:0
s_add_u32 s98, s98, 73728
buffer_load_dwordx4 v[44:47], v9, s[20:23], s98 offen nt
s_waitcnt lgkmcnt(6)
v_mfma_f32_16x16x32_bf16 v[88:91], v[112:115], v[108:111], v[88:91]
v_mov_b32_dpp v105, v121 row_shl:12 row_mask:0xf bank_mask:0x1 bound_ctrl:0
s_waitcnt lgkmcnt(4)
v_mfma_f32_16x16x32_bf16 v[92:95], v[116:119], v[108:111], v[92:95]
v_mov_b32_dpp v106, v120 row_shl:14 row_mask:0xf bank_mask:0x1 bound_ctrl:0
s_waitcnt lgkmcnt(2)
v_mfma_f32_16x16x32_bf16 v[96:99], v[124:127], v[108:111], v[96:99]
v_mov_b32_dpp v107, v121 row_shl:14 row_mask:0xf bank_mask:0x1 bound_ctrl:0
s_waitcnt lgkmcnt(0)
v_mfma_f32_16x16x32_bf16 v[100:103], v[12:15], v[108:111], v[100:103]
v_mov_b32_dpp v108, v122 row_shl:12 row_mask:0xf bank_mask:0x1 bound_ctrl:0
v_mfma_f32_16x16x32_bf16 v[72:75], v[224:227], v[104:107], v[72:75]
v_mfma_f32_16x16x32_bf16 v[76:79], v[228:231], v[104:107], v[76:79]
v_mov_b32_dpp v109, v123 row_shl:12 row_mask:0xf bank_mask:0x1 bound_ctrl:0
v_mfma_f32_16x16x32_bf16 v[80:83], v[232:235], v[104:107], v[80:83]
v_mfma_f32_16x16x32_bf16 v[84:87], v[236:239], v[104:107], v[84:87]
v_mov_b32_dpp v110, v122 row_shl:14 row_mask:0xf bank_mask:0x1 bound_ctrl:0
v_mfma_f32_16x16x32_bf16 v[88:91], v[240:243], v[104:107], v[88:91]
v_mfma_f32_16x16x32_bf16 v[92:95], v[244:247], v[104:107], v[92:95]
v_mov_b32_dpp v111, v123 row_shl:14 row_mask:0xf bank_mask:0x1 bound_ctrl:0
v_mfma_f32_16x16x32_bf16 v[96:99], v[248:251], v[104:107], v[96:99]
v_mfma_f32_16x16x32_bf16 v[100:103], v[252:255], v[104:107], v[100:103]
s_waitcnt vmcnt(8)
ds_read_b64_tr_b16 v[112:113], v2 offset:24576
ds_read_b64_tr_b16 v[114:115], v2 offset:28672
v_xor_b32 v10, 32, v2
ds_read_b64_tr_b16 v[116:117], v10 offset:24576
ds_read_b64_tr_b16 v[118:119], v10 offset:28672
v_xor_b32 v10, 64, v2
ds_read_b64_tr_b16 v[124:125], v10 offset:24576
ds_read_b64_tr_b16 v[126:127], v10 offset:28672
v_xor_b32 v10, 96, v2
ds_read_b64_tr_b16 v[12:13], v10 offset:24576
ds_read_b64_tr_b16 v[14:15], v10 offset:28672
s_waitcnt lgkmcnt(6)
v_mfma_f32_16x16x32_bf16 v[72:75], v[112:115], v[108:111], v[72:75]
v_xor_b32 v10, 128, v2
ds_read_b64_tr_b16 v[112:113], v10 offset:24576
ds_read_b64_tr_b16 v[114:115], v10 offset:28672
s_waitcnt lgkmcnt(6)
v_mfma_f32_16x16x32_bf16 v[76:79], v[116:119], v[108:111], v[76:79]
v_xor_b32 v10, 160, v2
ds_read_b64_tr_b16 v[116:117], v10 offset:24576
ds_read_b64_tr_b16 v[118:119], v10 offset:28672
s_waitcnt lgkmcnt(6)
v_mfma_f32_16x16x32_bf16 v[80:83], v[124:127], v[108:111], v[80:83]
v_xor_b32 v10, 192, v2
ds_read_b64_tr_b16 v[124:125], v10 offset:24576
ds_read_b64_tr_b16 v[126:127], v10 offset:28672
s_waitcnt lgkmcnt(6)
v_mfma_f32_16x16x32_bf16 v[84:87], v[12:15], v[108:111], v[84:87]
v_xor_b32 v10, 224, v2
ds_read_b64_tr_b16 v[12:13], v10 offset:24576
ds_read_b64_tr_b16 v[14:15], v10 offset:28672
s_waitcnt lgkmcnt(6)
v_mfma_f32_16x16x32_bf16 v[88:91], v[112:115], v[108:111], v[88:91]
s_waitcnt lgkmcnt(4)
v_mfma_f32_16x16x32_bf16 v[92:95], v[116:119], v[108:111], v[92:95]
v_mov_b32 v120, v72
v_mov_b32 v121, v73
s_waitcnt lgkmcnt(2)
v_mfma_f32_16x16x32_bf16 v[96:99], v[124:127], v[108:111], v[96:99]
v_mov_b32 v122, v74
v_mov_b32 v123, v75
s_waitcnt lgkmcnt(0)
v_mfma_f32_16x16x32_bf16 v[100:103], v[12:15], v[108:111], v[100:103]
v_mov_b32_dpp v120, v76 row_shr:2 row_mask:0xf bank_mask:0xf
v_mov_b32_dpp v121, v77 row_shr:2 row_mask:0xf bank_mask:0xf
v_add_f32_dpp v5, v5, v5 row_ror:2 row_mask:0xf bank_mask:0xf
s_nop 1
v_add_f32_dpp v5, v5, v5 row_ror:4 row_mask:0xf bank_mask:0xf
s_nop 1
v_add_f32_dpp v5, v5, v5 row_ror:8 row_mask:0xf bank_mask:0xf
v_mov_b32 v104, v5
v_mov_b32_dpp v122, v78 row_shr:2 row_mask:0xf bank_mask:0xf
v_mov_b32_dpp v123, v79 row_shr:2 row_mask:0xf bank_mask:0xf
v_permlane16_swap_b32 v5, v104
v_mov_b32_dpp v120, v80 row_shr:4 row_mask:0xf bank_mask:0xf
v_mov_b32_dpp v121, v81 row_shr:4 row_mask:0xf bank_mask:0xf
v_add_f32 v5, v5, v104
v_mov_b32_dpp v122, v82 row_shr:4 row_mask:0xf bank_mask:0xf
v_mov_b32_dpp v123, v83 row_shr:4 row_mask:0xf bank_mask:0xf
v_mov_b32 v104, v5
v_mov_b32_dpp v120, v84 row_shr:6 row_mask:0xf bank_mask:0xf
v_mov_b32_dpp v121, v85 row_shr:6 row_mask:0xf bank_mask:0xf
v_permlane32_swap_b32 v5, v104
v_mov_b32_dpp v122, v86 row_shr:6 row_mask:0xf bank_mask:0xf
v_mov_b32_dpp v123, v87 row_shr:6 row_mask:0xf bank_mask:0xf
v_add_f32 v5, v5, v104
v_mov_b32_dpp v120, v88 row_shr:8 row_mask:0xf bank_mask:0xf
v_mov_b32_dpp v121, v89 row_shr:8 row_mask:0xf bank_mask:0xf
v_mov_b32_dpp v122, v90 row_shr:8 row_mask:0xf bank_mask:0xf
v_mov_b32_dpp v123, v91 row_shr:8 row_mask:0xf bank_mask:0xf
v_mov_b32_dpp v120, v92 row_shr:10 row_mask:0xf bank_mask:0xf
v_mov_b32_dpp v121, v93 row_shr:10 row_mask:0xf bank_mask:0xf
v_mov_b32_dpp v122, v94 row_shr:10 row_mask:0xf bank_mask:0xf
v_mov_b32_dpp v123, v95 row_shr:10 row_mask:0xf bank_mask:0xf
v_mov_b32_dpp v120, v96 row_shr:12 row_mask:0xf bank_mask:0xf
v_mov_b32_dpp v121, v97 row_shr:12 row_mask:0xf bank_mask:0xf
v_mov_b32_dpp v122, v98 row_shr:12 row_mask:0xf bank_mask:0xf
v_mov_b32_dpp v123, v99 row_shr:12 row_mask:0xf bank_mask:0xf
v_mov_b32_dpp v120, v100 row_shr:14 row_mask:0xf bank_mask:0xf
v_mov_b32_dpp v121, v101 row_shr:14 row_mask:0xf bank_mask:0xf
v_mov_b32_dpp v122, v102 row_shr:14 row_mask:0xf bank_mask:0xf
v_mov_b32_dpp v123, v103 row_shr:14 row_mask:0xf bank_mask:0xf
s_add_u32 s98, s98, 516096
buffer_load_dwordx4 v[48:51], v9, s[20:23], s98 offen nt
s_add_u32 s98, s98, 73728
buffer_load_dwordx4 v[52:55], v9, s[20:23], s98 offen nt
s_add_u32 s98, s98, 516096
buffer_load_dwordx4 v[56:59], v9, s[20:23], s98 offen nt
s_branch Ljoin_17
LstreamW_16:
s_add_u32 s55, s54, 327680
buffer_load_dwordx4 a[80:83], v6, s[4:7], s55 offen offset:0 nt
buffer_load_dwordx4 a[84:87], v6, s[4:7], s55 offen offset:64 nt
buffer_load_dwordx4 a[88:91], v6, s[4:7], s55 offen offset:128 nt
buffer_load_dwordx4 a[92:95], v6, s[4:7], s55 offen offset:192 nt
s_add_u32 s55, s54, 196608
s_add_u32 m0, s70, 12288
s_nop 0
buffer_load_dwordx4 v7, s[8:11], s55 offen offset:0 nt lds
buffer_load_dwordx4 v8, s[8:11], s55 offen offset:1024 nt lds
buffer_load_dwordx4 v7, s[8:11], s55 offen offset:2048 nt lds
buffer_load_dwordx4 v8, s[8:11], s55 offen offset:3072 nt lds
s_sub_u32 s55, s49, 18
s_cmp_lt_u32 s55, 12
s_cbranch_scc0 Lnwo_34
s_add_u32 s63, s63, 32256
s_lshl_b32 s56, s3, 11
s_add_u32 m0, s56, 155648
s_nop 0
buffer_load_dwordx4 v5, s[16:19], s63 offen nt lds
s_add_u32 s63, s63, 4608
s_lshl_b32 s56, s3, 11
s_add_u32 m0, s56, 156672
s_nop 0
buffer_load_dwordx4 v5, s[16:19], s63 offen nt lds
Lnwo_34:
s_add_u32 s55, s54, 393216
buffer_load_dwordx4 a[96:99], v6, s[4:7], s55 offen offset:0 nt
buffer_load_dwordx4 a[100:103], v6, s[4:7], s55 offen offset:64 nt
buffer_load_dwordx4 a[104:107], v6, s[4:7], s55 offen offset:128 nt
buffer_load_dwordx4 a[108:111], v6, s[4:7], s55 offen offset:192 nt
s_waitcnt vmcnt(20)
ds_read_b64_tr_b16 v[128:129], v2 offset:0
ds_read_b64_tr_b16 v[130:131], v2 offset:4096
v_xor_b32 v15, 32, v2
ds_read_b64_tr_b16 v[132:133], v15 offset:0
ds_read_b64_tr_b16 v[134:135], v15 offset:4096
v_xor_b32 v15, 64, v2
ds_read_b64_tr_b16 v[136:137], v15 offset:0
ds_read_b64_tr_b16 v[138:139], v15 offset:4096
v_xor_b32 v15, 96, v2
ds_read_b64_tr_b16 v[140:141], v15 offset:0
ds_read_b64_tr_b16 v[142:143], v15 offset:4096
v_xor_b32 v15, 128, v2
ds_read_b64_tr_b16 v[144:145], v15 offset:0
ds_read_b64_tr_b16 v[146:147], v15 offset:4096
v_xor_b32 v15, 160, v2
ds_read_b64_tr_b16 v[148:149], v15 offset:0
ds_read_b64_tr_b16 v[150:151], v15 offset:4096
v_xor_b32 v15, 192, v2
ds_read_b64_tr_b16 v[152:153], v15 offset:0
ds_read_b64_tr_b16 v[154:155], v15 offset:4096
v_xor_b32 v15, 224, v2
ds_read_b64_tr_b16 v[156:157], v15 offset:0
ds_read_b64_tr_b16 v[158:159], v15 offset:4096
s_waitcnt lgkmcnt(0)
s_add_u32 s55, s54, 262144
s_add_u32 m0, s70, 16384
s_nop 0
buffer_load_dwordx4 v7, s[8:11], s55 offen offset:0 nt lds
buffer_load_dwordx4 v8, s[8:11], s55 offen offset:1024 nt lds
buffer_load_dwordx4 v7, s[8:11], s55 offen offset:2048 nt lds
buffer_load_dwordx4 v8, s[8:11], s55 offen offset:3072 nt lds
s_add_u32 s55, s54, 458752
buffer_load_dwordx4 a[112:115], v6, s[4:7], s55 offen offset:0 nt
buffer_load_dwordx4 a[116:119], v6, s[4:7], s55 offen offset:64 nt
buffer_load_dwordx4 a[120:123], v6, s[4:7], s55 offen offset:128 nt
buffer_load_dwordx4 a[124:127], v6, s[4:7], s55 offen offset:192 nt
s_add_u32 s55, s54, 327680
s_add_u32 m0, s70, 20480
s_nop 0
buffer_load_dwordx4 v7, s[8:11], s55 offen offset:0 nt lds
buffer_load_dwordx4 v8, s[8:11], s55 offen offset:1024 nt lds
buffer_load_dwordx4 v7, s[8:11], s55 offen offset:2048 nt lds
buffer_load_dwordx4 v8, s[8:11], s55 offen offset:3072 nt lds
s_waitcnt vmcnt(16)
ds_read_b64_tr_b16 v[160:161], v2 offset:8192
ds_read_b64_tr_b16 v[162:163], v2 offset:12288
v_xor_b32 v15, 32, v2
ds_read_b64_tr_b16 v[164:165], v15 offset:8192
ds_read_b64_tr_b16 v[166:167], v15 offset:12288
v_xor_b32 v15, 64, v2
ds_read_b64_tr_b16 v[168:169], v15 offset:8192
ds_read_b64_tr_b16 v[170:171], v15 offset:12288
v_xor_b32 v15, 96, v2
ds_read_b64_tr_b16 v[172:173], v15 offset:8192
ds_read_b64_tr_b16 v[174:175], v15 offset:12288
v_xor_b32 v15, 128, v2
ds_read_b64_tr_b16 v[176:177], v15 offset:8192
ds_read_b64_tr_b16 v[178:179], v15 offset:12288
v_xor_b32 v15, 160, v2
ds_read_b64_tr_b16 v[180:181], v15 offset:8192
ds_read_b64_tr_b16 v[182:183], v15 offset:12288
v_xor_b32 v15, 192, v2
ds_read_b64_tr_b16 v[184:185], v15 offset:8192
ds_read_b64_tr_b16 v[186:187], v15 offset:12288
v_xor_b32 v15, 224, v2
ds_read_b64_tr_b16 v[188:189], v15 offset:8192
ds_read_b64_tr_b16 v[190:191], v15 offset:12288
s_waitcnt lgkmcnt(0)
s_add_u32 s55, s54, 524288
buffer_load_dwordx4 a[128:131], v6, s[4:7], s55 offen offset:0 nt
buffer_load_dwordx4 a[132:135], v6, s[4:7], s55 offen offset:64 nt
buffer_load_dwordx4 a[136:139], v6, s[4:7], s55 offen offset:128 nt
buffer_load_dwordx4 a[140:143], v6, s[4:7], s55 offen offset:192 nt
s_sub_u32 s55, s49, 18
s_cmp_lt_u32 s55, 12
s_cbranch_scc0 Lnwo_35
s_waitcnt vmcnt(16)
v_lshrrev_b32 v14, 4, v0
v_bfe_u32 v15, v0, 2, 2
v_lshl_add_u32 v14, v14, 3, v15
v_lshlrev_b32 v10, 8, v14
v_and_b32 v15, 3, v0
v_lshl_add_u32 v10, v15, 3, v10
s_lshl_b32 s56, s3, 1
s_add_u32 s55, s3, 2
s_min_u32 s56, s56, s55
s_lshl_b32 s56, s56, 5
s_and_b32 s55, s49, 1
s_lshl_b32 s55, s55, 6
s_add_u32 s56, s56, s55
v_add_u32 v10, s56, v10
v_add_u32 v11, 131072, v10
v_add_u32 v12, 65536, v10
s_barrier
v_mov_b32 v9, v5
s_mov_b32 s98, s63
ds_read_b64_tr_b16 v[16:17], v11 offset:0
ds_read_b64_tr_b16 v[18:19], v11 offset:1024
ds_read_b64_tr_b16 v[20:21], v11 offset:32
ds_read_b64_tr_b16 v[22:23], v11 offset:1056
ds_read_b64_tr_b16 v[24:25], v11 offset:8192
ds_read_b64_tr_b16 v[26:27], v11 offset:9216
ds_read_b64_tr_b16 v[28:29], v11 offset:8224
ds_read_b64_tr_b16 v[30:31], v11 offset:9248
ds_read_b64_tr_b16 v[32:33], v11 offset:16384
ds_read_b64_tr_b16 v[34:35], v11 offset:17408
ds_read_b64_tr_b16 v[36:37], v11 offset:16416
ds_read_b64_tr_b16 v[38:39], v11 offset:17440
ds_read_b64_tr_b16 v[40:41], v11 offset:24576
ds_read_b64_tr_b16 v[42:43], v11 offset:25600
ds_read_b64_tr_b16 v[44:45], v11 offset:24608
ds_read_b64_tr_b16 v[46:47], v11 offset:25632
s_waitcnt lgkmcnt(0)
s_barrier
Lnwo_35:
s_add_u32 s55, s54, 393216
s_add_u32 m0, s70, 24576
s_nop 0
buffer_load_dwordx4 v7, s[8:11], s55 offen offset:0 nt lds
buffer_load_dwordx4 v8, s[8:11], s55 offen offset:1024 nt lds
buffer_load_dwordx4 v7, s[8:11], s55 offen offset:2048 nt lds
buffer_load_dwordx4 v8, s[8:11], s55 offen offset:3072 nt lds
s_add_u32 s55, s54, 589824
buffer_load_dwordx4 a[144:147], v6, s[4:7], s55 offen offset:0 nt
buffer_load_dwordx4 a[148:151], v6, s[4:7], s55 offen offset:64 nt
buffer_load_dwordx4 a[152:155], v6, s[4:7], s55 offen offset:128 nt
buffer_load_dwordx4 a[156:159], v6, s[4:7], s55 offen offset:192 nt
s_add_u32 s55, s54, 458752
s_add_u32 m0, s70, 28672
s_nop 0
buffer_load_dwordx4 v7, s[8:11], s55 offen offset:0 nt lds
buffer_load_dwordx4 v8, s[8:11], s55 offen offset:1024 nt lds
buffer_load_dwordx4 v7, s[8:11], s55 offen offset:2048 nt lds
buffer_load_dwordx4 v8, s[8:11], s55 offen offset:3072 nt lds
s_add_u32 s55, s54, 655360
buffer_load_dwordx4 a[160:163], v6, s[4:7], s55 offen offset:0 nt
buffer_load_dwordx4 a[164:167], v6, s[4:7], s55 offen offset:64 nt
buffer_load_dwordx4 a[168:171], v6, s[4:7], s55 offen offset:128 nt
buffer_load_dwordx4 a[172:175], v6, s[4:7], s55 offen offset:192 nt
s_add_u32 s55, s54, 524288
s_add_u32 m0, s70, 0
s_nop 0
buffer_load_dwordx4 v7, s[8:11], s55 offen offset:0 nt lds
buffer_load_dwordx4 v8, s[8:11], s55 offen offset:1024 nt lds
buffer_load_dwordx4 v7, s[8:11], s55 offen offset:2048 nt lds
buffer_load_dwordx4 v8, s[8:11], s55 offen offset:3072 nt lds
s_waitcnt vmcnt(24)
ds_read_b64_tr_b16 v[192:193], v2 offset:16384
ds_read_b64_tr_b16 v[194:195], v2 offset:20480
v_xor_b32 v15, 32, v2
ds_read_b64_tr_b16 v[196:197], v15 offset:16384
ds_read_b64_tr_b16 v[198:199], v15 offset:20480
v_xor_b32 v15, 64, v2
ds_read_b64_tr_b16 v[200:201], v15 offset:16384
ds_read_b64_tr_b16 v[202:203], v15 offset:20480
v_xor_b32 v15, 96, v2
ds_read_b64_tr_b16 v[204:205], v15 offset:16384
ds_read_b64_tr_b16 v[206:207], v15 offset:20480
v_xor_b32 v15, 128, v2
ds_read_b64_tr_b16 v[208:209], v15 offset:16384
ds_read_b64_tr_b16 v[210:211], v15 offset:20480
v_xor_b32 v15, 160, v2
ds_read_b64_tr_b16 v[212:213], v15 offset:16384
ds_read_b64_tr_b16 v[214:215], v15 offset:20480
v_xor_b32 v15, 192, v2
ds_read_b64_tr_b16 v[216:217], v15 offset:16384
ds_read_b64_tr_b16 v[218:219], v15 offset:20480
v_xor_b32 v15, 224, v2
ds_read_b64_tr_b16 v[220:221], v15 offset:16384
ds_read_b64_tr_b16 v[222:223], v15 offset:20480
s_waitcnt lgkmcnt(0)
s_add_u32 s55, s54, 720896
buffer_load_dwordx4 a[176:179], v6, s[4:7], s55 offen offset:0 nt
buffer_load_dwordx4 a[180:183], v6, s[4:7], s55 offen offset:64 nt
buffer_load_dwordx4 a[184:187], v6, s[4:7], s55 offen offset:128 nt
buffer_load_dwordx4 a[188:191], v6, s[4:7], s55 offen offset:192 nt
v_lshlrev_b32 v14, 5, v0
s_mov_b64 exec, 0xff
buffer_load_dwordx2 v[12:13], v14, s[44:47], 0 offen sc1
s_mov_b64 exec, -1
s_add_u32 s55, s54, 589824
s_add_u32 m0, s70, 4096
s_nop 0
buffer_load_dwordx4 v7, s[8:11], s55 offen offset:0 nt lds
buffer_load_dwordx4 v8, s[8:11], s55 offen offset:1024 nt lds
buffer_load_dwordx4 v7, s[8:11], s55 offen offset:2048 nt lds
buffer_load_dwordx4 v8, s[8:11], s55 offen offset:3072 nt lds
s_waitcnt vmcnt(17)
ds_read_b64_tr_b16 v[224:225], v2 offset:24576
ds_read_b64_tr_b16 v[226:227], v2 offset:28672
v_xor_b32 v15, 32, v2
ds_read_b64_tr_b16 v[228:229], v15 offset:24576
ds_read_b64_tr_b16 v[230:231], v15 offset:28672
v_xor_b32 v15, 64, v2
ds_read_b64_tr_b16 v[232:233], v15 offset:24576
ds_read_b64_tr_b16 v[234:235], v15 offset:28672
v_xor_b32 v15, 96, v2
ds_read_b64_tr_b16 v[236:237], v15 offset:24576
ds_read_b64_tr_b16 v[238:239], v15 offset:28672
v_xor_b32 v15, 128, v2
ds_read_b64_tr_b16 v[240:241], v15 offset:24576
ds_read_b64_tr_b16 v[242:243], v15 offset:28672
v_xor_b32 v15, 160, v2
ds_read_b64_tr_b16 v[244:245], v15 offset:24576
ds_read_b64_tr_b16 v[246:247], v15 offset:28672
v_xor_b32 v15, 192, v2
ds_read_b64_tr_b16 v[248:249], v15 offset:24576
ds_read_b64_tr_b16 v[250:251], v15 offset:28672
v_xor_b32 v15, 224, v2
ds_read_b64_tr_b16 v[252:253], v15 offset:24576
ds_read_b64_tr_b16 v[254:255], v15 offset:28672
s_waitcnt lgkmcnt(0)
s_add_u32 s55, s54, 786432
buffer_load_dwordx4 a[192:195], v6, s[4:7], s55 offen offset:0 nt
buffer_load_dwordx4 a[196:199], v6, s[4:7], s55 offen offset:64 nt
buffer_load_dwordx4 a[200:203], v6, s[4:7], s55 offen offset:128 nt
buffer_load_dwordx4 a[204:207], v6, s[4:7], s55 offen offset:192 nt
s_add_u32 s55, s54, 655360
s_add_u32 m0, s70, 8192
s_nop 0
buffer_load_dwordx4 v7, s[8:11], s55 offen offset:0 nt lds
buffer_load_dwordx4 v8, s[8:11], s55 offen offset:1024 nt lds
buffer_load_dwordx4 v7, s[8:11], s55 offen offset:2048 nt lds
buffer_load_dwordx4 v8, s[8:11], s55 offen offset:3072 nt lds
s_waitcnt vmcnt(12)
s_mov_b32 s52, 0
Lbp_36:
s_mov_b64 exec, 0xff
v_sad_u8 v11, v12, 0, 0
v_sad_u8 v11, v13, 0, v11
v_cmp_gt_u32 vcc, 32, v11
s_cbranch_vccz Lbd_37
s_sleep 8
v_lshlrev_b32 v14, 5, v0
buffer_load_dwordx2 v[12:13], v14, s[44:47], 0 offen sc1
s_waitcnt vmcnt(0)
s_add_u32 s52, s52, 1
s_cmp_lt_u32 s52, s51
s_cbranch_scc1 Lbp_36
s_mov_b32 s51, 0
Lbd_37:
s_mov_b64 exec, -1
v_readlane_b32 s58, v12, s48
v_readlane_b32 s59, v13, s48
s_bcnt1_i32_b64 s50, s[58:59]
s_cmp_eq_u32 s50, 1
s_cbranch_scc1 Lloc_38
v_mov_b32 v124, -1
v_mov_b32 v125, -1
v_mov_b32 v126, -1
v_mov_b32 v127, -1
s_mov_b32 exec_hi, 15
buffer_store_dwordx4 v[124:127], v1, s[40:43], s72 offen sc1
s_mov_b64 exec, 1
s_waitcnt vmcnt(0)
s_lshl_b32 s56, s48, 5
v_mov_b32 v14, s56
v_mov_b32 v11, 1
buffer_atomic_add v11, v14, s[44:47], 0 offen offset:8 sc1
s_mov_b32 s52, 0
Lb2_39:
s_sleep 8
buffer_load_dword v11, v14, s[44:47], 0 offen offset:8 sc1
s_waitcnt vmcnt(0)
v_cmp_gt_u32 vcc, 0x80, v11
s_cbranch_vccz Lloc_38
s_add_u32 s52, s52, 1
s_cmp_lt_u32 s52, s51
s_cbranch_scc1 Lb2_39
s_mov_b32 s51, 0
Lloc_38:
s_mov_b64 exec, -1
v_bfe_u32 v15, v0, 1, 2
v_lshrrev_b32 v10, 4, v0
v_lshl_add_u32 v15, v15, 2, v10
v_lshlrev_b32 v10, 7, v15
v_and_b32 v15, 1, v0
v_lshl_add_u32 v10, v15, 11, v10
v_bfe_u32 v15, v0, 3, 1
v_lshl_add_u32 v10, v15, 6, v10
s_cmp_lt_u32 s3, 2
s_cbranch_scc0 Lw_40
buffer_load_dwordx4 v[76:79], v10, s[40:43], s99 offen sc1
Lw_40:
s_mov_b32 exec_hi, 15
buffer_load_dwordx4 v[124:127], v1, s[40:43], s72 offen sc1
s_mov_b64 exec, -1
s_add_u32 s55, s54, 851968
buffer_load_dwordx4 a[208:211], v6, s[4:7], s55 offen offset:0 nt
buffer_load_dwordx4 a[212:215], v6, s[4:7], s55 offen offset:64 nt
buffer_load_dwordx4 a[216:219], v6, s[4:7], s55 offen offset:128 nt
buffer_load_dwordx4 a[220:223], v6, s[4:7], s55 offen offset:192 nt
s_add_u32 s55, s54, 720896
s_add_u32 m0, s70, 12288
s_nop 0
buffer_load_dwordx4 v7, s[8:11], s55 offen offset:0 nt lds
buffer_load_dwordx4 v8, s[8:11], s55 offen offset:1024 nt lds
buffer_load_dwordx4 v7, s[8:11], s55 offen offset:2048 nt lds
buffer_load_dwordx4 v8, s[8:11], s55 offen offset:3072 nt lds
s_waitcnt vmcnt(17)
ds_read_b64_tr_b16 v[80:81], v2 offset:0
ds_read_b64_tr_b16 v[82:83], v2 offset:4096
v_xor_b32 v15, 32, v2
ds_read_b64_tr_b16 v[84:85], v15 offset:0
ds_read_b64_tr_b16 v[86:87], v15 offset:4096
v_xor_b32 v15, 64, v2
ds_read_b64_tr_b16 v[88:89], v15 offset:0
ds_read_b64_tr_b16 v[90:91], v15 offset:4096
v_xor_b32 v15, 96, v2
ds_read_b64_tr_b16 v[92:93], v15 offset:0
ds_read_b64_tr_b16 v[94:95], v15 offset:4096
v_xor_b32 v15, 128, v2
ds_read_b64_tr_b16 v[96:97], v15 offset:0
ds_read_b64_tr_b16 v[98:99], v15 offset:4096
v_xor_b32 v15, 160, v2
ds_read_b64_tr_b16 v[100:101], v15 offset:0
ds_read_b64_tr_b16 v[102:103], v15 offset:4096
v_xor_b32 v15, 192, v2
ds_read_b64_tr_b16 v[104:105], v15 offset:0
ds_read_b64_tr_b16 v[106:107], v15 offset:4096
v_xor_b32 v15, 224, v2
ds_read_b64_tr_b16 v[108:109], v15 offset:0
ds_read_b64_tr_b16 v[110:111], v15 offset:4096
v_add_u32 v15, s70, v1
s_waitcnt lgkmcnt(0)
ds_write_b128 v15, v[80:83] offset:0
ds_write_b128 v15, v[84:87] offset:1024
ds_write_b128 v15, v[88:91] offset:2048
ds_write_b128 v15, v[92:95] offset:3072
ds_write_b128 v15, v[96:99] offset:4096
ds_write_b128 v15, v[100:103] offset:5120
ds_write_b128 v15, v[104:107] offset:6144
ds_write_b128 v15, v[108:111] offset:7168
s_add_u32 s55, s54, 917504
buffer_load_dwordx4 a[224:227], v6, s[4:7], s55 offen offset:0 nt
buffer_load_dwordx4 a[228:231], v6, s[4:7], s55 offen offset:64 nt
buffer_load_dwordx4 a[232:235], v6, s[4:7], s55 offen offset:128 nt
buffer_load_dwordx4 a[236:239], v6, s[4:7], s55 offen offset:192 nt
s_add_u32 s55, s54, 786432
s_add_u32 m0, s70, 16384
s_nop 0
buffer_load_dwordx4 v7, s[8:11], s55 offen offset:0 nt lds
buffer_load_dwordx4 v8, s[8:11], s55 offen offset:1024 nt lds
buffer_load_dwordx4 v7, s[8:11], s55 offen offset:2048 nt lds
buffer_load_dwordx4 v8, s[8:11], s55 offen offset:3072 nt lds
s_waitcnt vmcnt(8)
s_waitcnt lgkmcnt(0)
ds_read_b64_tr_b16 v[80:81], v2 offset:8192
ds_read_b64_tr_b16 v[82:83], v2 offset:12288
v_xor_b32 v15, 32, v2
ds_read_b64_tr_b16 v[84:85], v15 offset:8192
ds_read_b64_tr_b16 v[86:87], v15 offset:12288
v_xor_b32 v15, 64, v2
ds_read_b64_tr_b16 v[88:89], v15 offset:8192
ds_read_b64_tr_b16 v[90:91], v15 offset:12288
v_xor_b32 v15, 96, v2
ds_read_b64_tr_b16 v[92:93], v15 offset:8192
ds_read_b64_tr_b16 v[94:95], v15 offset:12288
v_xor_b32 v15, 128, v2
ds_read_b64_tr_b16 v[96:97], v15 offset:8192
ds_read_b64_tr_b16 v[98:99], v15 offset:12288
v_xor_b32 v15, 160, v2
ds_read_b64_tr_b16 v[100:101], v15 offset:8192
ds_read_b64_tr_b16 v[102:103], v15 offset:12288
v_xor_b32 v15, 192, v2
ds_read_b64_tr_b16 v[104:105], v15 offset:8192
ds_read_b64_tr_b16 v[106:107], v15 offset:12288
v_xor_b32 v15, 224, v2
ds_read_b64_tr_b16 v[108:109], v15 offset:8192
ds_read_b64_tr_b16 v[110:111], v15 offset:12288
v_add_u32 v15, s70, v1
s_waitcnt lgkmcnt(0)
ds_write_b128 v15, v[80:83] offset:8192
ds_write_b128 v15, v[84:87] offset:9216
ds_write_b128 v15, v[88:91] offset:10240
ds_write_b128 v15, v[92:95] offset:11264
ds_write_b128 v15, v[96:99] offset:12288
ds_write_b128 v15, v[100:103] offset:13312
ds_write_b128 v15, v[104:107] offset:14336
ds_write_b128 v15, v[108:111] offset:15360
s_cmp_lt_u32 s3, 2
s_cbranch_scc0 Lw_41
s_mov_b32 s52, -1
v_cmp_eq_u32 vcc, -1, v76
s_cbranch_vccz Lqok_42
s_mov_b32 s52, 0
Lpoll_43:
buffer_load_dwordx4 v[76:79], v10, s[40:43], s99 offen sc1
s_waitcnt vmcnt(0)
v_cmp_eq_u32 vcc, -1, v76
s_cbranch_vccnz Lpretry_44
Lpdone_45:
Lqok_42:
ds_write_b128 v4, v[76:79]
s_waitcnt lgkmcnt(0)
Lw_41:
s_waitcnt lgkmcnt(0)
s_barrier
v_add_u32 v10, 155648, v1
ds_read_b128 v[76:79], v10
ds_read_b128 v[80:83], v10 offset:2048
s_waitcnt lgkmcnt(0)
v_add_f32 v76, v76, v80
v_add_f32 v77, v77, v81
v_add_f32 v78, v78, v82
v_add_f32 v79, v79, v83
v_mov_b32_dpp v80, v76 row_shl:8 row_mask:0xf bank_mask:0xf
v_mov_b32_dpp v81, v77 row_shl:8 row_mask:0xf bank_mask:0xf
v_mov_b32_dpp v82, v78 row_shl:8 row_mask:0xf bank_mask:0xf
v_mov_b32_dpp v83, v79 row_shl:8 row_mask:0xf bank_mask:0xf
v_cvt_pk_bf16_f32 v88, v76, v77
v_cvt_pk_bf16_f32 v89, v78, v79
v_cvt_pk_bf16_f32 v90, v80, v81
v_cvt_pk_bf16_f32 v91, v82, v83
v_mov_b32 v72, 0
v_mov_b32 v73, 0
v_mov_b32 v74, 0
v_mov_b32 v75, 0
v_mov_b32 v76, 0
v_mov_b32 v77, 0
v_mov_b32 v78, 0
v_mov_b32 v79, 0
v_mov_b32 v80, 0
v_mov_b32 v81, 0
v_mov_b32 v82, 0
v_mov_b32 v83, 0
v_mov_b32 v84, 0
v_mov_b32 v85, 0
v_mov_b32 v86, 0
v_mov_b32 v87, 0
v_mov_b32_dpp v72, v88 quad_perm:[0,1,2,3] row_mask:0xf bank_mask:0x1
v_mov_b32_dpp v73, v89 quad_perm:[0,1,2,3] row_mask:0xf bank_mask:0x1
v_mov_b32_dpp v74, v90 quad_perm:[0,1,2,3] row_mask:0xf bank_mask:0x1
v_mov_b32_dpp v75, v91 quad_perm:[0,1,2,3] row_mask:0xf bank_mask:0x1
v_mov_b32_dpp v76, v88 row_shl:2 row_mask:0xf bank_mask:0x1
v_mov_b32_dpp v77, v89 row_shl:2 row_mask:0xf bank_mask:0x1
v_mov_b32_dpp v78, v90 row_shl:2 row_mask:0xf bank_mask:0x1
v_mov_b32_dpp v79, v91 row_shl:2 row_mask:0xf bank_mask:0x1
v_mov_b32_dpp v80, v88 row_shl:4 row_mask:0xf bank_mask:0x1
v_mov_b32_dpp v81, v89 row_shl:4 row_mask:0xf bank_mask:0x1
v_mov_b32_dpp v82, v90 row_shl:4 row_mask:0xf bank_mask:0x1
v_mov_b32_dpp v83, v91 row_shl:4 row_mask:0xf bank_mask:0x1
v_mov_b32_dpp v84, v88 row_shl:6 row_mask:0xf bank_mask:0x1
v_mov_b32_dpp v85, v89 row_shl:6 row_mask:0xf bank_mask:0x1
v_mov_b32_dpp v86, v90 row_shl:6 row_mask:0xf bank_mask:0x1
v_mov_b32_dpp v87, v91 row_shl:6 row_mask:0xf bank_mask:0x1
v_mfma_f32_16x16x32_bf16 v[88:91], a[0:3], v[72:75], 0
v_mfma_f32_16x16x32_bf16 v[88:91], a[4:7], v[76:79], v[88:91]
v_mfma_f32_16x16x32_bf16 v[88:91], a[8:11], v[80:83], v[88:91]
v_mfma_f32_16x16x32_bf16 v[88:91], a[12:15], v[84:87], v[88:91]
v_mfma_f32_16x16x32_bf16 v[92:95], a[16:19], v[72:75], 0
v_mfma_f32_16x16x32_bf16 v[92:95], a[20:23], v[76:79], v[92:95]
v_mfma_f32_16x16x32_bf16 v[92:95], a[24:27], v[80:83], v[92:95]
v_mfma_f32_16x16x32_bf16 v[92:95], a[28:31], v[84:87], v[92:95]
v_mfma_f32_16x16x32_bf16 v[96:99], a[32:35], v[72:75], 0
s_nop 2
v_mov_b32 v100, v88
v_mfma_f32_16x16x32_bf16 v[96:99], a[36:39], v[76:79], v[96:99]
v_mov_b32 v101, v89
v_mfma_f32_16x16x32_bf16 v[96:99], a[40:43], v[80:83], v[96:99]
v_mov_b32 v102, v90
v_mfma_f32_16x16x32_bf16 v[96:99], a[44:47], v[84:87], v[96:99]
v_mov_b32 v103, v91
v_mfma_f32_16x16x32_bf16 v[88:91], a[48:51], v[72:75], 0
v_mov_b32_dpp v100, v92 row_shr:2 row_mask:0xf bank_mask:0xf
v_mfma_f32_16x16x32_bf16 v[88:91], a[52:55], v[76:79], v[88:91]
v_mov_b32_dpp v101, v93 row_shr:2 row_mask:0xf bank_mask:0xf
v_mfma_f32_16x16x32_bf16 v[88:91], a[56:59], v[80:83], v[88:91]
v_mov_b32_dpp v102, v94 row_shr:2 row_mask:0xf bank_mask:0xf
v_mfma_f32_16x16x32_bf16 v[88:91], a[60:63], v[84:87], v[88:91]
v_mov_b32_dpp v103, v95 row_shr:2 row_mask:0xf bank_mask:0xf
v_mfma_f32_16x16x32_bf16 v[92:95], a[64:67], v[72:75], 0
v_mov_b32_dpp v100, v96 row_shr:4 row_mask:0xf bank_mask:0xf
v_mfma_f32_16x16x32_bf16 v[92:95], a[68:71], v[76:79], v[92:95]
v_mov_b32_dpp v101, v97 row_shr:4 row_mask:0xf bank_mask:0xf
v_mfma_f32_16x16x32_bf16 v[92:95], a[72:75], v[80:83], v[92:95]
v_mov_b32_dpp v102, v98 row_shr:4 row_mask:0xf bank_mask:0xf
v_mfma_f32_16x16x32_bf16 v[92:95], a[76:79], v[84:87], v[92:95]
v_mov_b32_dpp v103, v99 row_shr:4 row_mask:0xf bank_mask:0xf
v_mfma_f32_16x16x32_bf16 v[96:99], a[80:83], v[72:75], 0
v_mov_b32_dpp v100, v88 row_shr:6 row_mask:0xf bank_mask:0xf
v_mfma_f32_16x16x32_bf16 v[96:99], a[84:87], v[76:79], v[96:99]
v_mov_b32_dpp v101, v89 row_shr:6 row_mask:0xf bank_mask:0xf
v_mfma_f32_16x16x32_bf16 v[96:99], a[88:91], v[80:83], v[96:99]
v_mov_b32_dpp v102, v90 row_shr:6 row_mask:0xf bank_mask:0xf
v_mfma_f32_16x16x32_bf16 v[96:99], a[92:95], v[84:87], v[96:99]
v_mov_b32_dpp v103, v91 row_shr:6 row_mask:0xf bank_mask:0xf
s_add_u32 s55, s54, 983040
s_lshl_b32 s56, s3, 12
s_add_u32 m0, s56, 131072
s_nop 0
buffer_load_dwordx4 v6, s[4:7], s55 offen offset:0 nt lds
s_lshl_b32 s56, s3, 12
s_add_u32 m0, s56, 132032
s_nop 0
buffer_load_dwordx4 v6, s[4:7], s55 offen offset:64 nt lds
s_lshl_b32 s56, s3, 12
s_add_u32 m0, s56, 132992
s_nop 0
buffer_load_dwordx4 v6, s[4:7], s55 offen offset:128 nt lds
s_lshl_b32 s56, s3, 12
s_add_u32 m0, s56, 133952
s_nop 0
buffer_load_dwordx4 v6, s[4:7], s55 offen offset:192 nt lds
s_add_u32 s55, s54, 851968
s_add_u32 m0, s70, 20480
s_nop 0
buffer_load_dwordx4 v7, s[8:11], s55 offen offset:0 nt lds
buffer_load_dwordx4 v8, s[8:11], s55 offen offset:1024 nt lds
buffer_load_dwordx4 v7, s[8:11], s55 offen offset:2048 nt lds
buffer_load_dwordx4 v8, s[8:11], s55 offen offset:3072 nt lds
v_mfma_f32_16x16x32_bf16 v[88:91], a[96:99], v[72:75], 0
v_mov_b32_dpp v100, v92 row_shr:8 row_mask:0xf bank_mask:0xf
v_mfma_f32_16x16x32_bf16 v[88:91], a[100:103], v[76:79], v[88:91]
v_mov_b32_dpp v101, v93 row_shr:8 row_mask:0xf bank_mask:0xf
v_mfma_f32_16x16x32_bf16 v[88:91], a[104:107], v[80:83], v[88:91]
v_mov_b32_dpp v102, v94 row_shr:8 row_mask:0xf bank_mask:0xf
v_mfma_f32_16x16x32_bf16 v[88:91], a[108:111], v[84:87], v[88:91]
v_mov_b32_dpp v103, v95 row_shr:8 row_mask:0xf bank_mask:0xf
v_mfma_f32_16x16x32_bf16 v[92:95], a[112:115], v[72:75], 0
v_mov_b32_dpp v100, v96 row_shr:10 row_mask:0xf bank_mask:0xf
v_mfma_f32_16x16x32_bf16 v[92:95], a[116:119], v[76:79], v[92:95]
v_mov_b32_dpp v101, v97 row_shr:10 row_mask:0xf bank_mask:0xf
v_mfma_f32_16x16x32_bf16 v[92:95], a[120:123], v[80:83], v[92:95]
v_mov_b32_dpp v102, v98 row_shr:10 row_mask:0xf bank_mask:0xf
v_mfma_f32_16x16x32_bf16 v[92:95], a[124:127], v[84:87], v[92:95]
v_mov_b32_dpp v103, v99 row_shr:10 row_mask:0xf bank_mask:0xf
v_mfma_f32_16x16x32_bf16 v[96:99], a[128:131], v[72:75], 0
v_mov_b32_dpp v100, v88 row_shr:12 row_mask:0xf bank_mask:0xf
v_mfma_f32_16x16x32_bf16 v[96:99], a[132:135], v[76:79], v[96:99]
v_mov_b32_dpp v101, v89 row_shr:12 row_mask:0xf bank_mask:0xf
v_mfma_f32_16x16x32_bf16 v[96:99], a[136:139], v[80:83], v[96:99]
v_mov_b32_dpp v102, v90 row_shr:12 row_mask:0xf bank_mask:0xf
v_mfma_f32_16x16x32_bf16 v[96:99], a[140:143], v[84:87], v[96:99]
v_mov_b32_dpp v103, v91 row_shr:12 row_mask:0xf bank_mask:0xf
v_mfma_f32_16x16x32_bf16 v[88:91], a[144:147], v[72:75], 0
v_mov_b32_dpp v100, v92 row_shr:14 row_mask:0xf bank_mask:0xf
v_mfma_f32_16x16x32_bf16 v[88:91], a[148:151], v[76:79], v[88:91]
v_mov_b32_dpp v101, v93 row_shr:14 row_mask:0xf bank_mask:0xf
v_mfma_f32_16x16x32_bf16 v[88:91], a[152:155], v[80:83], v[88:91]
v_mov_b32_dpp v102, v94 row_shr:14 row_mask:0xf bank_mask:0xf
v_mfma_f32_16x16x32_bf16 v[88:91], a[156:159], v[84:87], v[88:91]
v_mov_b32_dpp v103, v95 row_shr:14 row_mask:0xf bank_mask:0xf
v_mfma_f32_16x16x32_bf16 v[92:95], a[160:163], v[72:75], 0
v_mov_b32 v104, v96
v_mfma_f32_16x16x32_bf16 v[92:95], a[164:167], v[76:79], v[92:95]
v_mov_b32 v105, v97
v_mfma_f32_16x16x32_bf16 v[92:95], a[168:171], v[80:83], v[92:95]
v_mov_b32 v106, v98
v_mfma_f32_16x16x32_bf16 v[92:95], a[172:175], v[84:87], v[92:95]
v_mov_b32 v107, v99
v_mfma_f32_16x16x32_bf16 v[96:99], a[176:179], v[72:75], 0
v_mov_b32_dpp v104, v88 row_shr:2 row_mask:0xf bank_mask:0xf
v_mfma_f32_16x16x32_bf16 v[96:99], a[180:183], v[76:79], v[96:99]
v_mov_b32_dpp v105, v89 row_shr:2 row_mask:0xf bank_mask:0xf
v_mfma_f32_16x16x32_bf16 v[96:99], a[184:187], v[80:83], v[96:99]
v_mov_b32_dpp v106, v90 row_shr:2 row_mask:0xf bank_mask:0xf
v_mfma_f32_16x16x32_bf16 v[96:99], a[188:191], v[84:87], v[96:99]
v_mov_b32_dpp v107, v91 row_shr:2 row_mask:0xf bank_mask:0xf
s_add_u32 s55, s54, 917504
s_add_u32 m0, s70, 24576
s_nop 0
buffer_load_dwordx4 v7, s[8:11], s55 offen offset:0 nt lds
buffer_load_dwordx4 v8, s[8:11], s55 offen offset:1024 nt lds
buffer_load_dwordx4 v7, s[8:11], s55 offen offset:2048 nt lds
buffer_load_dwordx4 v8, s[8:11], s55 offen offset:3072 nt lds
s_add_u32 s55, s54, 983040
s_add_u32 m0, s70, 28672
s_nop 0
buffer_load_dwordx4 v7, s[8:11], s55 offen offset:0 nt lds
buffer_load_dwordx4 v8, s[8:11], s55 offen offset:1024 nt lds
buffer_load_dwordx4 v7, s[8:11], s55 offen offset:2048 nt lds
buffer_load_dwordx4 v8, s[8:11], s55 offen offset:3072 nt lds
v_mfma_f32_16x16x32_bf16 v[88:91], a[192:195], v[72:75], 0
v_mov_b32_dpp v104, v92 row_shr:4 row_mask:0xf bank_mask:0xf
v_mfma_f32_16x16x32_bf16 v[88:91], a[196:199], v[76:79], v[88:91]
v_mov_b32_dpp v105, v93 row_shr:4 row_mask:0xf bank_mask:0xf
v_mfma_f32_16x16x32_bf16 v[88:91], a[200:203], v[80:83], v[88:91]
v_mov_b32_dpp v106, v94 row_shr:4 row_mask:0xf bank_mask:0xf
v_mfma_f32_16x16x32_bf16 v[88:91], a[204:207], v[84:87], v[88:91]
v_mov_b32_dpp v107, v95 row_shr:4 row_mask:0xf bank_mask:0xf
s_waitcnt vmcnt(28)
v_mfma_f32_16x16x32_bf16 v[92:95], a[208:211], v[72:75], 0
v_mov_b32_dpp v104, v96 row_shr:6 row_mask:0xf bank_mask:0xf
v_mfma_f32_16x16x32_bf16 v[92:95], a[212:215], v[76:79], v[92:95]
v_mov_b32_dpp v105, v97 row_shr:6 row_mask:0xf bank_mask:0xf
v_mfma_f32_16x16x32_bf16 v[92:95], a[216:219], v[80:83], v[92:95]
v_mov_b32_dpp v106, v98 row_shr:6 row_mask:0xf bank_mask:0xf
v_mfma_f32_16x16x32_bf16 v[92:95], a[220:223], v[84:87], v[92:95]
v_mov_b32_dpp v107, v99 row_shr:6 row_mask:0xf bank_mask:0xf
s_waitcnt vmcnt(20)
v_mfma_f32_16x16x32_bf16 v[96:99], a[224:227], v[72:75], 0
v_mov_b32_dpp v104, v88 row_shr:8 row_mask:0xf bank_mask:0xf
v_mfma_f32_16x16x32_bf16 v[96:99], a[228:231], v[76:79], v[96:99]
v_mov_b32_dpp v105, v89 row_shr:8 row_mask:0xf bank_mask:0xf
v_mfma_f32_16x16x32_bf16 v[96:99], a[232:235], v[80:83], v[96:99]
v_mov_b32_dpp v106, v90 row_shr:8 row_mask:0xf bank_mask:0xf
v_mfma_f32_16x16x32_bf16 v[96:99], a[236:239], v[84:87], v[96:99]
v_mov_b32_dpp v107, v91 row_shr:8 row_mask:0xf bank_mask:0xf
s_waitcnt vmcnt(12)
s_lshl_b32 s56, s3, 12
s_add_u32 s56, s56, 131072
v_add_u32 v11, s56, v1
ds_read_b128 v[108:111], v11 offset:0
ds_read_b128 v[112:115], v11 offset:1024
ds_read_b128 v[116:119], v11 offset:2048
ds_read_b128 v[120:123], v11 offset:3072
s_waitcnt lgkmcnt(0)
v_mfma_f32_16x16x32_bf16 v[88:91], v[108:111], v[72:75], 0
v_mov_b32_dpp v104, v92 row_shr:10 row_mask:0xf bank_mask:0xf
v_mfma_f32_16x16x32_bf16 v[88:91], v[112:115], v[76:79], v[88:91]
v_mov_b32_dpp v105, v93 row_shr:10 row_mask:0xf bank_mask:0xf
v_mfma_f32_16x16x32_bf16 v[88:91], v[116:119], v[80:83], v[88:91]
v_mov_b32_dpp v106, v94 row_shr:10 row_mask:0xf bank_mask:0xf
v_mfma_f32_16x16x32_bf16 v[88:91], v[120:123], v[84:87], v[88:91]
v_mov_b32_dpp v107, v95 row_shr:10 row_mask:0xf bank_mask:0xf
v_mov_b32_dpp v104, v96 row_shr:12 row_mask:0xf bank_mask:0xf
v_mov_b32_dpp v105, v97 row_shr:12 row_mask:0xf bank_mask:0xf
v_mov_b32_dpp v106, v98 row_shr:12 row_mask:0xf bank_mask:0xf
v_mov_b32_dpp v107, v99 row_shr:12 row_mask:0xf bank_mask:0xf
v_add_u32 v10, s70, v1
ds_read_b128 v[112:115], v10 offset:0
ds_read_b128 v[116:119], v10 offset:1024
ds_read_b128 v[124:127], v10 offset:2048
ds_read_b128 v[12:15], v10 offset:3072
v_max3_f32 v11, v100, v101, v102
v_mov_b32_dpp v104, v88 row_shr:14 row_mask:0xf bank_mask:0xf
v_mov_b32_dpp v105, v89 row_shr:14 row_mask:0xf bank_mask:0xf
v_mov_b32_dpp v106, v90 row_shr:14 row_mask:0xf bank_mask:0xf
v_mov_b32_dpp v107, v91 row_shr:14 row_mask:0xf bank_mask:0xf
v_max3_f32 v88, v103, v104, v105
v_max3_f32 v11, v11, v106, v107
v_max_f32 v11, v11, v88
s_nop 1
v_max_f32_dpp v11, v11, v11 row_ror:2 row_mask:0xf bank_mask:0xf
s_nop 1
v_max_f32_dpp v11, v11, v11 row_ror:4 row_mask:0xf bank_mask:0xf
s_nop 1
v_max_f32_dpp v11, v11, v11 row_ror:8 row_mask:0xf bank_mask:0xf
v_mov_b32 v88, v11
s_nop 1
v_permlane16_swap_b32 v11, v88
v_max_f32 v11, v11, v88
v_mov_b32 v88, v11
s_nop 1
v_permlane32_swap_b32 v11, v88
v_max_f32 v11, v11, v88
v_mul_f32 v11, s60, v11
v_fma_f32 v100, v100, s60, -v11
v_fma_f32 v101, v101, s60, -v11
v_fma_f32 v102, v102, s60, -v11
v_fma_f32 v103, v103, s60, -v11
v_fma_f32 v104, v104, s60, -v11
v_fma_f32 v105, v105, s60, -v11
v_fma_f32 v106, v106, s60, -v11
v_fma_f32 v107, v107, s60, -v11
v_exp_f32 v100, v100
v_exp_f32 v101, v101
v_exp_f32 v102, v102
v_exp_f32 v103, v103
v_exp_f32 v104, v104
v_exp_f32 v105, v105
v_exp_f32 v106, v106
v_exp_f32 v107, v107
v_cvt_pk_bf16_f32 v120, v100, v101
v_cvt_pk_bf16_f32 v121, v102, v103
v_cvt_pk_bf16_f32 v122, v104, v105
v_cvt_pk_bf16_f32 v123, v106, v107
v_add_f32 v5, v104, v105
v_add_f32 v88, v106, v107
v_add_f32 v5, v5, v88
v_mov_b32 v104, 0
v_mov_b32 v105, 0
v_mov_b32 v106, 0
v_mov_b32 v107, 0
v_mov_b32 v108, 0
v_mov_b32 v109, 0
v_mov_b32 v110, 0
v_mov_b32 v111, 0
v_mov_b32_dpp v104, v120 quad_perm:[0,1,2,3] row_mask:0xf bank_mask:0x1 bound_ctrl:0
v_mov_b32_dpp v105, v121 quad_perm:[0,1,2,3] row_mask:0xf bank_mask:0x1 bound_ctrl:0
v_mov_b32_dpp v106, v120 row_shl:2 row_mask:0xf bank_mask:0x1 bound_ctrl:0
v_mov_b32_dpp v107, v121 row_shl:2 row_mask:0xf bank_mask:0x1 bound_ctrl:0
v_mov_b32_dpp v108, v122 quad_perm:[0,1,2,3] row_mask:0xf bank_mask:0x1 bound_ctrl:0
v_mov_b32_dpp v109, v123 quad_perm:[0,1,2,3] row_mask:0xf bank_mask:0x1 bound_ctrl:0
v_mov_b32_dpp v110, v122 row_shl:2 row_mask:0xf bank_mask:0x1 bound_ctrl:0
v_mov_b32_dpp v111, v123 row_shl:2 row_mask:0xf bank_mask:0x1 bound_ctrl:0
v_mfma_f32_16x16x32_bf16 v[72:75], v[128:131], v[104:107], 0
v_add_f32 v5, v5, v100
s_add_u32 s98, s98, 32256
buffer_load_dwordx4 v[48:51], v9, s[16:19], s98 offen nt
v_mfma_f32_16x16x32_bf16 v[76:79], v[132:135], v[104:107], 0
v_add_f32 v5, v5, v101
v_mfma_f32_16x16x32_bf16 v[80:83], v[136:139], v[104:107], 0
v_add_f32 v5, v5, v102
v_mfma_f32_16x16x32_bf16 v[84:87], v[140:143], v[104:107], 0
v_add_f32 v5, v5, v103
s_waitcnt lgkmcnt(3)
v_mfma_f32_16x16x32_bf16 v[72:75], v[112:115], v[108:111], v[72:75]
ds_read_b128 v[112:115], v10 offset:4096
s_waitcnt lgkmcnt(3)
v_mfma_f32_16x16x32_bf16 v[76:79], v[116:119], v[108:111], v[76:79]
ds_read_b128 v[116:119], v10 offset:5120
s_waitcnt lgkmcnt(3)
v_mfma_f32_16x16x32_bf16 v[80:83], v[124:127], v[108:111], v[80:83]
ds_read_b128 v[124:127], v10 offset:6144
s_add_u32 s98, s98, 4608
buffer_load_dwordx4 v[52:55], v9, s[16:19], s98 offen nt
s_waitcnt lgkmcnt(3)
v_mfma_f32_16x16x32_bf16 v[84:87], v[12:15], v[108:111], v[84:87]
ds_read_b128 v[12:15], v10 offset:7168
v_mfma_f32_16x16x32_bf16 v[88:91], v[144:147], v[104:107], 0
v_mfma_f32_16x16x32_bf16 v[92:95], v[148:151], v[104:107], 0
v_mfma_f32_16x16x32_bf16 v[96:99], v[152:155], v[104:107], 0
v_mfma_f32_16x16x32_bf16 v[100:103], v[156:159], v[104:107], 0
v_mov_b32_dpp v104, v120 row_shl:4 row_mask:0xf bank_mask:0x1 bound_ctrl:0
s_waitcnt lgkmcnt(3)
v_mfma_f32_16x16x32_bf16 v[88:91], v[112:115], v[108:111], v[88:91]
ds_read_b128 v[112:115], v10 offset:8192
v_mov_b32_dpp v105, v121 row_shl:4 row_mask:0xf bank_mask:0x1 bound_ctrl:0
s_add_u32 s98, s98, 32256
buffer_load_dwordx4 v[56:59], v9, s[16:19], s98 offen nt
s_waitcnt lgkmcnt(3)
v_mfma_f32_16x16x32_bf16 v[92:95], v[116:119], v[108:111], v[92:95]
ds_read_b128 v[116:119], v10 offset:9216
v_mov_b32_dpp v106, v120 row_shl:6 row_mask:0xf bank_mask:0x1 bound_ctrl:0
s_waitcnt lgkmcnt(3)
v_mfma_f32_16x16x32_bf16 v[96:99], v[124:127], v[108:111], v[96:99]
ds_read_b128 v[124:127], v10 offset:10240
v_mov_b32_dpp v107, v121 row_shl:6 row_mask:0xf bank_mask:0x1 bound_ctrl:0
s_waitcnt lgkmcnt(3)
v_mfma_f32_16x16x32_bf16 v[100:103], v[12:15], v[108:111], v[100:103]
ds_read_b128 v[12:15], v10 offset:11264
v_mov_b32_dpp v108, v122 row_shl:4 row_mask:0xf bank_mask:0x1 bound_ctrl:0
v_mfma_f32_16x16x32_bf16 v[72:75], v[160:163], v[104:107], v[72:75]
v_mov_b32_dpp v109, v123 row_shl:4 row_mask:0xf bank_mask:0x1 bound_ctrl:0
v_mfma_f32_16x16x32_bf16 v[76:79], v[164:167], v[104:107], v[76:79]
v_mov_b32_dpp v110, v122 row_shl:6 row_mask:0xf bank_mask:0x1 bound_ctrl:0
v_mfma_f32_16x16x32_bf16 v[80:83], v[168:171], v[104:107], v[80:83]
v_mov_b32_dpp v111, v123 row_shl:6 row_mask:0xf bank_mask:0x1 bound_ctrl:0
s_add_u32 s98, s98, 4608
buffer_load_dwordx4 v[60:63], v9, s[16:19], s98 offen nt
v_mfma_f32_16x16x32_bf16 v[84:87], v[172:175], v[104:107], v[84:87]
s_waitcnt lgkmcnt(3)
v_mfma_f32_16x16x32_bf16 v[72:75], v[112:115], v[108:111], v[72:75]
ds_read_b128 v[112:115], v10 offset:12288
s_waitcnt lgkmcnt(3)
v_mfma_f32_16x16x32_bf16 v[76:79], v[116:119], v[108:111], v[76:79]
ds_read_b128 v[116:119], v10 offset:13312
s_waitcnt lgkmcnt(3)
v_mfma_f32_16x16x32_bf16 v[80:83], v[124:127], v[108:111], v[80:83]
ds_read_b128 v[124:127], v10 offset:14336
s_waitcnt lgkmcnt(3)
v_mfma_f32_16x16x32_bf16 v[84:87], v[12:15], v[108:111], v[84:87]
ds_read_b128 v[12:15], v10 offset:15360
v_mfma_f32_16x16x32_bf16 v[88:91], v[176:179], v[104:107], v[88:91]
s_add_u32 s98, s98, 32256
buffer_load_dwordx4 v[64:67], v9, s[16:19], s98 offen nt
v_mfma_f32_16x16x32_bf16 v[92:95], v[180:183], v[104:107], v[92:95]
v_mfma_f32_16x16x32_bf16 v[96:99], v[184:187], v[104:107], v[96:99]
v_mfma_f32_16x16x32_bf16 v[100:103], v[188:191], v[104:107], v[100:103]
v_mov_b32_dpp v104, v120 row_shl:8 row_mask:0xf bank_mask:0x1 bound_ctrl:0
s_waitcnt vmcnt(13)
s_waitcnt lgkmcnt(3)
v_mfma_f32_16x16x32_bf16 v[88:91], v[112:115], v[108:111], v[88:91]
ds_read_b64_tr_b16 v[112:113], v2 offset:16384
ds_read_b64_tr_b16 v[114:115], v2 offset:20480
v_mov_b32_dpp v105, v121 row_shl:8 row_mask:0xf bank_mask:0x1 bound_ctrl:0
s_waitcnt lgkmcnt(4)
v_mfma_f32_16x16x32_bf16 v[92:95], v[116:119], v[108:111], v[92:95]
v_xor_b32 v10, 32, v2
ds_read_b64_tr_b16 v[116:117], v10 offset:16384
ds_read_b64_tr_b16 v[118:119], v10 offset:20480
v_mov_b32_dpp v106, v120 row_shl:10 row_mask:0xf bank_mask:0x1 bound_ctrl:0
s_waitcnt lgkmcnt(5)
v_mfma_f32_16x16x32_bf16 v[96:99], v[124:127], v[108:111], v[96:99]
v_xor_b32 v10, 64, v2
ds_read_b64_tr_b16 v[124:125], v10 offset:16384
ds_read_b64_tr_b16 v[126:127], v10 offset:20480
v_mov_b32_dpp v107, v121 row_shl:10 row_mask:0xf bank_mask:0x1 bound_ctrl:0
s_add_u32 s98, s98, 4608
buffer_load_dwordx4 v[68:71], v9, s[16:19], s98 offen nt
s_waitcnt lgkmcnt(6)
v_mfma_f32_16x16x32_bf16 v[100:103], v[12:15], v[108:111], v[100:103]
v_xor_b32 v10, 96, v2
ds_read_b64_tr_b16 v[12:13], v10 offset:16384
ds_read_b64_tr_b16 v[14:15], v10 offset:20480
v_mov_b32_dpp v108, v122 row_shl:8 row_mask:0xf bank_mask:0x1 bound_ctrl:0
v_mfma_f32_16x16x32_bf16 v[72:75], v[192:195], v[104:107], v[72:75]
v_mov_b32_dpp v109, v123 row_shl:8 row_mask:0xf bank_mask:0x1 bound_ctrl:0
v_mfma_f32_16x16x32_bf16 v[76:79], v[196:199], v[104:107], v[76:79]
v_mov_b32_dpp v110, v122 row_shl:10 row_mask:0xf bank_mask:0x1 bound_ctrl:0
v_mfma_f32_16x16x32_bf16 v[80:83], v[200:203], v[104:107], v[80:83]
v_mov_b32_dpp v111, v123 row_shl:10 row_mask:0xf bank_mask:0x1 bound_ctrl:0
v_mfma_f32_16x16x32_bf16 v[84:87], v[204:207], v[104:107], v[84:87]
s_waitcnt lgkmcnt(6)
v_mfma_f32_16x16x32_bf16 v[72:75], v[112:115], v[108:111], v[72:75]
v_xor_b32 v10, 128, v2
ds_read_b64_tr_b16 v[112:113], v10 offset:16384
ds_read_b64_tr_b16 v[114:115], v10 offset:20480
s_add_u32 s98, s98, 32256
buffer_load_dwordx4 a[240:243], v9, s[16:19], s98 offen nt
s_waitcnt lgkmcnt(6)
v_mfma_f32_16x16x32_bf16 v[76:79], v[116:119], v[108:111], v[76:79]
v_xor_b32 v10, 160, v2
ds_read_b64_tr_b16 v[116:117], v10 offset:16384
ds_read_b64_tr_b16 v[118:119], v10 offset:20480
s_waitcnt lgkmcnt(6)
v_mfma_f32_16x16x32_bf16 v[80:83], v[124:127], v[108:111], v[80:83]
v_xor_b32 v10, 192, v2
ds_read_b64_tr_b16 v[124:125], v10 offset:16384
ds_read_b64_tr_b16 v[126:127], v10 offset:20480
s_waitcnt lgkmcnt(6)
v_mfma_f32_16x16x32_bf16 v[84:87], v[12:15], v[108:111], v[84:87]
v_xor_b32 v10, 224, v2
ds_read_b64_tr_b16 v[12:13], v10 offset:16384
ds_read_b64_tr_b16 v[14:15], v10 offset:20480
v_mfma_f32_16x16x32_bf16 v[88:91], v[208:211], v[104:107], v[88:91]
v_mfma_f32_16x16x32_bf16 v[92:95], v[212:215], v[104:107], v[92:95]
v_mfma_f32_16x16x32_bf16 v[96:99], v[216:219], v[104:107], v[96:99]
s_add_u32 s98, s98, 4608
buffer_load_dwordx4 a[244:247], v9, s[16:19], s98 offen nt
v_mfma_f32_16x16x32_bf16 v[100:103], v[220:223], v[104:107], v[100:103]
v_mov_b32_dpp v104, v120 row_shl:12 row_mask:0xf bank_mask:0x1 bound_ctrl:0
s_waitcnt lgkmcnt(6)
v_mfma_f32_16x16x32_bf16 v[88:91], v[112:115], v[108:111], v[88:91]
v_mov_b32_dpp v105, v121 row_shl:12 row_mask:0xf bank_mask:0x1 bound_ctrl:0
s_waitcnt lgkmcnt(4)
v_mfma_f32_16x16x32_bf16 v[92:95], v[116:119], v[108:111], v[92:95]
v_mov_b32_dpp v106, v120 row_shl:14 row_mask:0xf bank_mask:0x1 bound_ctrl:0
s_waitcnt lgkmcnt(2)
v_mfma_f32_16x16x32_bf16 v[96:99], v[124:127], v[108:111], v[96:99]
v_mov_b32_dpp v107, v121 row_shl:14 row_mask:0xf bank_mask:0x1 bound_ctrl:0
s_waitcnt lgkmcnt(0)
v_mfma_f32_16x16x32_bf16 v[100:103], v[12:15], v[108:111], v[100:103]
v_mov_b32_dpp v108, v122 row_shl:12 row_mask:0xf bank_mask:0x1 bound_ctrl:0
v_mfma_f32_16x16x32_bf16 v[72:75], v[224:227], v[104:107], v[72:75]
v_mfma_f32_16x16x32_bf16 v[76:79], v[228:231], v[104:107], v[76:79]
v_mov_b32_dpp v109, v123 row_shl:12 row_mask:0xf bank_mask:0x1 bound_ctrl:0
v_mfma_f32_16x16x32_bf16 v[80:83], v[232:235], v[104:107], v[80:83]
v_mfma_f32_16x16x32_bf16 v[84:87], v[236:239], v[104:107], v[84:87]
v_mov_b32_dpp v110, v122 row_shl:14 row_mask:0xf bank_mask:0x1 bound_ctrl:0
v_mfma_f32_16x16x32_bf16 v[88:91], v[240:243], v[104:107], v[88:91]
v_mfma_f32_16x16x32_bf16 v[92:95], v[244:247], v[104:107], v[92:95]
v_mov_b32_dpp v111, v123 row_shl:14 row_mask:0xf bank_mask:0x1 bound_ctrl:0
v_mfma_f32_16x16x32_bf16 v[96:99], v[248:251], v[104:107], v[96:99]
v_mfma_f32_16x16x32_bf16 v[100:103], v[252:255], v[104:107], v[100:103]
s_waitcnt vmcnt(8)
ds_read_b64_tr_b16 v[112:113], v2 offset:24576
ds_read_b64_tr_b16 v[114:115], v2 offset:28672
v_xor_b32 v10, 32, v2
ds_read_b64_tr_b16 v[116:117], v10 offset:24576
ds_read_b64_tr_b16 v[118:119], v10 offset:28672
v_xor_b32 v10, 64, v2
ds_read_b64_tr_b16 v[124:125], v10 offset:24576
ds_read_b64_tr_b16 v[126:127], v10 offset:28672
v_xor_b32 v10, 96, v2
ds_read_b64_tr_b16 v[12:13], v10 offset:24576
ds_read_b64_tr_b16 v[14:15], v10 offset:28672
s_waitcnt lgkmcnt(6)
v_mfma_f32_16x16x32_bf16 v[72:75], v[112:115], v[108:111], v[72:75]
v_xor_b32 v10, 128, v2
ds_read_b64_tr_b16 v[112:113], v10 offset:24576
ds_read_b64_tr_b16 v[114:115], v10 offset:28672
s_waitcnt lgkmcnt(6)
v_mfma_f32_16x16x32_bf16 v[76:79], v[116:119], v[108:111], v[76:79]
v_xor_b32 v10, 160, v2
ds_read_b64_tr_b16 v[116:117], v10 offset:24576
ds_read_b64_tr_b16 v[118:119], v10 offset:28672
s_waitcnt lgkmcnt(6)
v_mfma_f32_16x16x32_bf16 v[80:83], v[124:127], v[108:111], v[80:83]
v_xor_b32 v10, 192, v2
ds_read_b64_tr_b16 v[124:125], v10 offset:24576
ds_read_b64_tr_b16 v[126:127], v10 offset:28672
s_waitcnt lgkmcnt(6)
v_mfma_f32_16x16x32_bf16 v[84:87], v[12:15], v[108:111], v[84:87]
v_xor_b32 v10, 224, v2
ds_read_b64_tr_b16 v[12:13], v10 offset:24576
ds_read_b64_tr_b16 v[14:15], v10 offset:28672
s_waitcnt lgkmcnt(6)
v_mfma_f32_16x16x32_bf16 v[88:91], v[112:115], v[108:111], v[88:91]
s_waitcnt lgkmcnt(4)
v_mfma_f32_16x16x32_bf16 v[92:95], v[116:119], v[108:111], v[92:95]
v_mov_b32 v120, v72
v_mov_b32 v121, v73
s_waitcnt lgkmcnt(2)
v_mfma_f32_16x16x32_bf16 v[96:99], v[124:127], v[108:111], v[96:99]
v_mov_b32 v122, v74
v_mov_b32 v123, v75
s_waitcnt lgkmcnt(0)
v_mfma_f32_16x16x32_bf16 v[100:103], v[12:15], v[108:111], v[100:103]
v_mov_b32_dpp v120, v76 row_shr:2 row_mask:0xf bank_mask:0xf
v_mov_b32_dpp v121, v77 row_shr:2 row_mask:0xf bank_mask:0xf
v_add_f32_dpp v5, v5, v5 row_ror:2 row_mask:0xf bank_mask:0xf
s_nop 1
v_add_f32_dpp v5, v5, v5 row_ror:4 row_mask:0xf bank_mask:0xf
s_nop 1
v_add_f32_dpp v5, v5, v5 row_ror:8 row_mask:0xf bank_mask:0xf
v_mov_b32 v104, v5
v_mov_b32_dpp v122, v78 row_shr:2 row_mask:0xf bank_mask:0xf
v_mov_b32_dpp v123, v79 row_shr:2 row_mask:0xf bank_mask:0xf
v_permlane16_swap_b32 v5, v104
v_mov_b32_dpp v120, v80 row_shr:4 row_mask:0xf bank_mask:0xf
v_mov_b32_dpp v121, v81 row_shr:4 row_mask:0xf bank_mask:0xf
v_add_f32 v5, v5, v104
v_mov_b32_dpp v122, v82 row_shr:4 row_mask:0xf bank_mask:0xf
v_mov_b32_dpp v123, v83 row_shr:4 row_mask:0xf bank_mask:0xf
v_mov_b32 v104, v5
v_mov_b32_dpp v120, v84 row_shr:6 row_mask:0xf bank_mask:0xf
v_mov_b32_dpp v121, v85 row_shr:6 row_mask:0xf bank_mask:0xf
v_permlane32_swap_b32 v5, v104
v_mov_b32_dpp v122, v86 row_shr:6 row_mask:0xf bank_mask:0xf
v_mov_b32_dpp v123, v87 row_shr:6 row_mask:0xf bank_mask:0xf
v_add_f32 v5, v5, v104
v_mov_b32_dpp v120, v88 row_shr:8 row_mask:0xf bank_mask:0xf
v_mov_b32_dpp v121, v89 row_shr:8 row_mask:0xf bank_mask:0xf
v_mov_b32_dpp v122, v90 row_shr:8 row_mask:0xf bank_mask:0xf
v_mov_b32_dpp v123, v91 row_shr:8 row_mask:0xf bank_mask:0xf
v_mov_b32_dpp v120, v92 row_shr:10 row_mask:0xf bank_mask:0xf
v_mov_b32_dpp v121, v93 row_shr:10 row_mask:0xf bank_mask:0xf
v_mov_b32_dpp v122, v94 row_shr:10 row_mask:0xf bank_mask:0xf
v_mov_b32_dpp v123, v95 row_shr:10 row_mask:0xf bank_mask:0xf
v_mov_b32_dpp v120, v96 row_shr:12 row_mask:0xf bank_mask:0xf
v_mov_b32_dpp v121, v97 row_shr:12 row_mask:0xf bank_mask:0xf
v_mov_b32_dpp v122, v98 row_shr:12 row_mask:0xf bank_mask:0xf
v_mov_b32_dpp v123, v99 row_shr:12 row_mask:0xf bank_mask:0xf
v_mov_b32_dpp v120, v100 row_shr:14 row_mask:0xf bank_mask:0xf
v_mov_b32_dpp v121, v101 row_shr:14 row_mask:0xf bank_mask:0xf
v_mov_b32_dpp v122, v102 row_shr:14 row_mask:0xf bank_mask:0xf
v_mov_b32_dpp v123, v103 row_shr:14 row_mask:0xf bank_mask:0xf
Ljoin_17:
s_lshl_b32 s55, s3, 10
s_add_u32 s55, s55, 147456
v_add_u32 v10, s55, v1
ds_write_b128 v10, v[120:123]
v_and_b32 v12, 1, v0
v_lshlrev_b32 v12, 3, v12
v_add_u32 v12, 151552, v12
s_lshl_b32 s55, s3, 4
v_add_u32 v13, s55, v12
s_mov_b64 exec, 3
ds_write2_b32 v13, v11, v5 offset0:0 offset1:1
s_mov_b64 exec, -1
s_waitcnt lgkmcnt(0)
s_barrier
s_cmp_eq_u32 s3, 0
s_cbranch_scc0 Lw_46
ds_read_b64 v[76:77], v12 offset:0
ds_read_b64 v[78:79], v12 offset:16
ds_read_b64 v[80:81], v12 offset:32
ds_read_b64 v[82:83], v12 offset:48
ds_read_b128 v[84:87], v10 offset:1024
ds_read_b128 v[88:91], v10 offset:2048
ds_read_b128 v[92:95], v10 offset:3072
v_and_b32 v12, 1, v0
v_lshlrev_b32 v12, 12, v12
v_bfe_u32 v13, v0, 2, 2
v_lshl_add_u32 v12, v13, 10, v12
v_bfe_u32 v13, v0, 1, 1
v_lshl_add_u32 v12, v13, 9, v12
v_lshrrev_b32 v13, 5, v0
v_lshl_add_u32 v12, v13, 8, v12
v_bfe_u32 v13, v0, 4, 1
v_lshl_add_u32 v12, v13, 3, v12
s_add_u32 s55, s66, 0
s_add_u32 s58, s67, 0
v_mov_b32 v14, 0
s_waitcnt lgkmcnt(3)
v_max3_f32 v96, v76, v78, v80
v_max_f32 v96, v96, v82
v_sub_f32 v76, v76, v96
v_sub_f32 v78, v78, v96
v_sub_f32 v80, v80, v96
v_sub_f32 v82, v82, v96
v_exp_f32 v76, v76
v_exp_f32 v78, v78
v_exp_f32 v80, v80
v_exp_f32 v82, v82
v_mul_f32 v97, v76, v77
v_fmac_f32 v97, v78, v79
v_fmac_f32 v97, v80, v81
v_fmac_f32 v97, v82, v83
v_rcp_f32 v13, v97
v_mul_f32 v120, v76, v120
v_mul_f32 v121, v76, v121
v_mul_f32 v122, v76, v122
v_mul_f32 v123, v76, v123
s_waitcnt lgkmcnt(0)
v_fmac_f32 v120, v78, v84
v_fmac_f32 v121, v78, v85
v_fmac_f32 v122, v78, v86
v_fmac_f32 v123, v78, v87
v_fmac_f32 v120, v80, v88
v_fmac_f32 v121, v80, v89
v_fmac_f32 v122, v80, v90
v_fmac_f32 v123, v80, v91
v_fmac_f32 v120, v82, v92
v_fmac_f32 v121, v82, v93
v_fmac_f32 v122, v82, v94
v_fmac_f32 v123, v82, v95
v_mul_f32 v120, v13, v120
v_mul_f32 v121, v13, v121
v_mul_f32 v122, v13, v122
v_mul_f32 v123, v13, v123
v_mov_b32_dpp v98, v96 quad_perm:[1,1,1,1] row_mask:0xf bank_mask:0xf
v_mov_b32_dpp v99, v97 quad_perm:[1,1,1,1] row_mask:0xf bank_mask:0xf
v_cvt_pk_bf16_f32 v120, v120, v121
v_cvt_pk_bf16_f32 v121, v122, v123
s_cmp_eq_u32 s50, 1
s_cbranch_scc0 Lpl_47
buffer_store_dwordx2 v[120:121], v12, s[40:43], s55 offen
s_mov_b64 exec, 1
buffer_store_dwordx4 v[96:99], v14, s[40:43], s58 offen
Lpe_48:
s_mov_b64 exec, -1
Lw_46:
s_barrier
s_cmp_lt_u32 s49, 18
s_cbranch_scc1 Lffn_49
s_cmp_lt_u32 s49, 30
s_cbranch_scc0 Lidle_50
v_lshrrev_b32 v14, 4, v0
v_bfe_u32 v15, v0, 2, 2
v_lshl_add_u32 v14, v14, 3, v15
s_lshl_b32 s55, s3, 11
s_add_u32 s55, s55, 147456
v_add_u32 v10, s55, v1
v_lshlrev_b32 v11, 8, v14
v_and_b32 v15, 3, v0
v_lshl_add_u32 v11, v15, 3, v11
s_lshl_b32 s56, s3, 1
s_add_u32 s55, s3, 2
s_min_u32 s56, s56, s55
s_lshl_b32 s56, s56, 5
s_and_b32 s55, s49, 1
s_lshl_b32 s55, s55, 6
s_add_u32 s56, s56, s55
s_add_u32 s56, s56, 147456
v_add_u32 v11, s56, v11
s_waitcnt vmcnt(6)
ds_write_b128 v10, v[48:51] offset:8192
ds_write_b128 v10, v[52:55] offset:9216
s_waitcnt lgkmcnt(0)
s_barrier
ds_read_b64_tr_b16 v[48:49], v11 offset:8192
ds_read_b64_tr_b16 v[50:51], v11 offset:9216
ds_read_b64_tr_b16 v[52:53], v11 offset:8224
ds_read_b64_tr_b16 v[54:55], v11 offset:9248
s_waitcnt vmcnt(4)
ds_write_b128 v10, v[56:59] offset:0
ds_write_b128 v10, v[60:63] offset:1024
s_waitcnt lgkmcnt(0)
s_barrier
ds_read_b64_tr_b16 v[56:57], v11 offset:0
ds_read_b64_tr_b16 v[58:59], v11 offset:1024
ds_read_b64_tr_b16 v[60:61], v11 offset:32
ds_read_b64_tr_b16 v[62:63], v11 offset:1056
s_waitcnt vmcnt(2)
ds_write_b128 v10, v[64:67] offset:8192
ds_write_b128 v10, v[68:71] offset:9216
s_waitcnt lgkmcnt(0)
s_barrier
ds_read_b64_tr_b16 v[64:65], v11 offset:8192
ds_read_b64_tr_b16 v[66:67], v11 offset:9216
ds_read_b64_tr_b16 v[68:69], v11 offset:8224
ds_read_b64_tr_b16 v[70:71], v11 offset:9248
s_waitcnt vmcnt(0)
ds_write_b128 v10, a[240:243] offset:0
ds_write_b128 v10, a[244:247] offset:1024
s_waitcnt lgkmcnt(0)
s_barrier
ds_read_b64_tr_b16 a[240:241], v11 offset:0
ds_read_b64_tr_b16 a[242:243], v11 offset:1024
ds_read_b64_tr_b16 a[244:245], v11 offset:32
ds_read_b64_tr_b16 a[246:247], v11 offset:1056
s_waitcnt lgkmcnt(0)
s_barrier
s_sub_u32 s59, s49, 18
s_mul_i32 s61, s59, 3
s_add_u32 s61, s61, s3
s_sub_u32 s61, s61, 1
s_cmp_lg_u32 s3, 0
s_cbranch_scc0 Lw_52
v_mov_b32 v13, 0
v_lshrrev_b32 v10, 4, v0
v_bfe_u32 v11, v0, 2, 2
v_and_b32 v14, 3, v0
v_mul_u32_u24 v12, 1152, v14
v_lshl_add_u32 v12, v11, 3, v12
v_lshl_add_u32 v5, v10, 1, v12
s_lshl_b32 s55, s61, 5
buffer_load_short_d16_hi v13, v5, s[32:35], s55 offen
v_lshlrev_b32 v12, 4, v14
v_and_b32 v15, 1, v11
v_lshl_add_u32 v12, v15, 3, v12
v_lshrrev_b32 v15, 1, v11
v_lshl_add_u32 v12, v15, 6, v12
v_lshrrev_b32 v10, 5, v0
v_lshl_add_u32 v12, v10, 2, v12
s_lshl_b32 s63, s61, 7
s_add_u32 s63, s63, s53
s_add_u32 s63, s63, 37888
Lw_52:
s_lshl_b32 s55, s62, 13
s_add_u32 s55, s55, s53
s_add_u32 s55, s55, 4096
s_lshl_b32 s56, s3, 11
s_add_u32 s55, s55, s56
s_add_u32 s57, s56, 147456
v_add_u32 v10, s57, v1
v_and_b32 v11, 0xff, v1
s_add_u32 s56, s56, 155648
v_add_u32 v126, s56, v11
v_add_u32 v127, 147456, v1
v_lshrrev_b32 v5, 4, v0
v_lshlrev_b32 v5, 6, v5
v_and_b32 v14, 3, v0
v_lshl_add_u32 v5, v14, 4, v5
s_add_u32 s58, s68, 0
s_cmp_eq_u32 s3, 0
s_cbranch_scc0 Lwoo_53
s_lshl_b32 s57, s62, 8
s_add_u32 s57, s57, s53
s_add_u32 s57, s57, 36864
v_lshrrev_b32 v12, 4, v0
v_lshl_add_u32 v12, v12, 11, v11
v_add_u32 v12, 155648, v12
s_mov_b32 s52, 0
Lpoll_55:
buffer_load_dwordx4 v[104:107], v1, s[40:43], s55 offen offset:0 sc1
buffer_load_dwordx4 v[108:111], v1, s[40:43], s55 offen offset:1024 sc1
buffer_load_dwordx4 v[112:115], v11, s[40:43], s57 offen sc1
s_waitcnt vmcnt(0)
v_max3_u32 v15, v104, v106, v108
v_max3_u32 v15, v15, v110, v112
v_cmp_eq_u32 vcc, -1, v15
s_cbranch_vccnz Lpretry_56
Lpdone_57:
ds_write_b128 v12, v[112:115]
s_branch Lwod_54
Lwoo_53:
s_mov_b32 s52, 0
Lpoll_58:
buffer_load_dwordx4 v[104:107], v1, s[40:43], s55 offen offset:0 sc1
buffer_load_dwordx4 v[108:111], v1, s[40:43], s55 offen offset:1024 sc1
s_waitcnt vmcnt(0)
v_max3_u32 v15, v104, v106, v108
v_max_u32 v15, v15, v110
v_cmp_eq_u32 vcc, -1, v15
s_cbranch_vccnz Lpretry_59
Lpdone_60:
Lwod_54:
ds_write_b128 v10, v[104:107]
ds_write_b128 v10, v[108:111] offset:1024
s_waitcnt lgkmcnt(0)
s_barrier
ds_read_b128 v[120:123], v126
ds_read_b128 v[72:75], v127 offset:0
ds_read_b128 v[76:79], v127 offset:1024
ds_read_b128 v[80:83], v127 offset:2048
ds_read_b128 v[84:87], v127 offset:3072
ds_read_b128 v[88:91], v127 offset:4096
ds_read_b128 v[92:95], v127 offset:5120
ds_read_b128 v[96:99], v127 offset:6144
ds_read_b128 v[100:103], v127 offset:7168
s_waitcnt lgkmcnt(8)
v_max_f32_dpp v124, v120, v120 row_ror:4 row_mask:0xf bank_mask:0xf
v_max_f32_dpp v125, v122, v122 row_ror:4 row_mask:0xf bank_mask:0xf
s_nop 0
v_max_f32_dpp v124, v124, v124 row_ror:8 row_mask:0xf bank_mask:0xf
v_max_f32_dpp v125, v125, v125 row_ror:8 row_mask:0xf bank_mask:0xf
s_waitcnt lgkmcnt(7)
v_mfma_f32_16x16x32_bf16 v[104:107], v[16:19], v[72:75], 0
v_sub_f32 v120, v120, v124
v_sub_f32 v122, v122, v125
s_waitcnt lgkmcnt(6)
v_mfma_f32_16x16x32_bf16 v[104:107], v[24:27], v[76:79], v[104:107]
v_exp_f32 v120, v120
v_exp_f32 v122, v122
s_waitcnt lgkmcnt(5)
v_mfma_f32_16x16x32_bf16 v[104:107], v[32:35], v[80:83], v[104:107]
v_mul_f32 v120, v120, v121
v_mul_f32 v122, v122, v123
s_waitcnt lgkmcnt(4)
v_mfma_f32_16x16x32_bf16 v[104:107], v[40:43], v[84:87], v[104:107]
v_add_f32_dpp v124, v120, v120 row_ror:4 row_mask:0xf bank_mask:0xf
v_add_f32_dpp v125, v122, v122 row_ror:4 row_mask:0xf bank_mask:0xf
s_waitcnt lgkmcnt(3)
v_mfma_f32_16x16x32_bf16 v[108:111], v[48:51], v[88:91], 0
v_add_f32_dpp v124, v124, v124 row_ror:8 row_mask:0xf bank_mask:0xf
v_add_f32_dpp v125, v125, v125 row_ror:8 row_mask:0xf bank_mask:0xf
s_waitcnt lgkmcnt(2)
v_mfma_f32_16x16x32_bf16 v[108:111], v[56:59], v[92:95], v[108:111]
v_rcp_f32 v124, v124
v_rcp_f32 v125, v125
s_waitcnt lgkmcnt(1)
v_mfma_f32_16x16x32_bf16 v[108:111], v[64:67], v[96:99], v[108:111]
v_mul_f32 v120, v120, v124
v_mul_f32 v122, v122, v125
s_waitcnt lgkmcnt(0)
v_mfma_f32_16x16x32_bf16 v[108:111], a[240:243], v[100:103], v[108:111]
s_cmp_ge_u32 s3, 2
s_cbranch_scc1 Lwo1t_61
v_mfma_f32_16x16x32_bf16 v[112:115], v[20:23], v[72:75], 0
v_mfma_f32_16x16x32_bf16 v[112:115], v[28:31], v[76:79], v[112:115]
v_mfma_f32_16x16x32_bf16 v[112:115], v[36:39], v[80:83], v[112:115]
v_mfma_f32_16x16x32_bf16 v[112:115], v[44:47], v[84:87], v[112:115]
v_mul_f32 v104, v120, v104
v_mul_f32 v105, v120, v105
v_mul_f32 v106, v120, v106
v_mfma_f32_16x16x32_bf16 v[116:119], v[52:55], v[88:91], 0
v_mul_f32 v107, v120, v107
v_fmac_f32 v104, v122, v108
v_fmac_f32 v105, v122, v109
v_mfma_f32_16x16x32_bf16 v[116:119], v[60:63], v[92:95], v[116:119]
v_fmac_f32 v106, v122, v110
v_fmac_f32 v107, v122, v111
v_add_f32_dpp v104, v104, v104 row_ror:4 row_mask:0xf bank_mask:0xf
v_mfma_f32_16x16x32_bf16 v[116:119], v[68:71], v[96:99], v[116:119]
v_add_f32_dpp v105, v105, v105 row_ror:4 row_mask:0xf bank_mask:0xf
v_add_f32_dpp v106, v106, v106 row_ror:4 row_mask:0xf bank_mask:0xf
v_add_f32_dpp v107, v107, v107 row_ror:4 row_mask:0xf bank_mask:0xf
v_mfma_f32_16x16x32_bf16 v[116:119], a[244:247], v[100:103], v[116:119]
v_add_f32_dpp v104, v104, v104 row_ror:8 row_mask:0xf bank_mask:0xf
v_add_f32_dpp v105, v105, v105 row_ror:8 row_mask:0xf bank_mask:0xf
v_add_f32_dpp v106, v106, v106 row_ror:8 row_mask:0xf bank_mask:0xf
v_add_f32_dpp v107, v107, v107 row_ror:8 row_mask:0xf bank_mask:0xf
s_mov_b64 exec, s[96:97]
buffer_store_dwordx4 v[104:107], v5, s[40:43], s58 offen offset:0 sc1
s_mov_b64 exec, -1
s_add_u32 s58, s58, 4096
v_mul_f32 v112, v120, v112
v_mul_f32 v113, v120, v113
v_mul_f32 v114, v120, v114
v_mul_f32 v115, v120, v115
v_fmac_f32 v112, v122, v116
v_fmac_f32 v113, v122, v117
v_fmac_f32 v114, v122, v118
v_fmac_f32 v115, v122, v119
v_add_f32_dpp v112, v112, v112 row_ror:4 row_mask:0xf bank_mask:0xf
v_add_f32_dpp v113, v113, v113 row_ror:4 row_mask:0xf bank_mask:0xf
v_add_f32_dpp v114, v114, v114 row_ror:4 row_mask:0xf bank_mask:0xf
v_add_f32_dpp v115, v115, v115 row_ror:4 row_mask:0xf bank_mask:0xf
v_add_f32_dpp v112, v112, v112 row_ror:8 row_mask:0xf bank_mask:0xf
v_add_f32_dpp v113, v113, v113 row_ror:8 row_mask:0xf bank_mask:0xf
v_add_f32_dpp v114, v114, v114 row_ror:8 row_mask:0xf bank_mask:0xf
v_add_f32_dpp v115, v115, v115 row_ror:8 row_mask:0xf bank_mask:0xf
s_mov_b64 exec, s[96:97]
buffer_store_dwordx4 v[112:115], v5, s[40:43], s58 offen offset:0 sc1
s_mov_b64 exec, -1
s_branch Lwof_62
Lwo1t_61:
v_mul_f32 v104, v120, v104
v_mul_f32 v105, v120, v105
v_mul_f32 v106, v120, v106
v_mul_f32 v107, v120, v107
s_nop 1
v_fmac_f32 v104, v122, v108
v_fmac_f32 v105, v122, v109
v_fmac_f32 v106, v122, v110
v_fmac_f32 v107, v122, v111
v_add_f32_dpp v104, v104, v104 row_ror:4 row_mask:0xf bank_mask:0xf
v_add_f32_dpp v105, v105, v105 row_ror:4 row_mask:0xf bank_mask:0xf
v_add_f32_dpp v106, v106, v106 row_ror:4 row_mask:0xf bank_mask:0xf
v_add_f32_dpp v107, v107, v107 row_ror:4 row_mask:0xf bank_mask:0xf
v_add_f32_dpp v104, v104, v104 row_ror:8 row_mask:0xf bank_mask:0xf
v_add_f32_dpp v105, v105, v105 row_ror:8 row_mask:0xf bank_mask:0xf
v_add_f32_dpp v106, v106, v106 row_ror:8 row_mask:0xf bank_mask:0xf
v_add_f32_dpp v107, v107, v107 row_ror:8 row_mask:0xf bank_mask:0xf
s_mov_b64 exec, s[96:97]
buffer_store_dwordx4 v[104:107], v5, s[40:43], s58 offen offset:0 sc1
s_mov_b64 exec, -1
Lwof_62:
s_cmp_lg_u32 s3, 0
s_cbranch_scc0 Lw_63
s_lshl_b32 s55, s61, 12
s_add_u32 s55, s55, 589824
s_waitcnt vmcnt(0)
s_mov_b32 s52, 0
Lpoll_64:
buffer_load_dwordx4 v[72:75], v1, s[40:43], s55 offen offset:0 sc1
buffer_load_dwordx4 v[76:79], v1, s[40:43], s55 offen offset:1024 sc1
buffer_load_dwordx4 v[80:83], v1, s[40:43], s55 offen offset:2048 sc1
buffer_load_dwordx4 v[84:87], v1, s[40:43], s55 offen offset:3072 sc1
s_waitcnt vmcnt(0)
v_max3_u32 v15, v72, v76, v80
v_max_u32 v15, v15, v84
v_cmp_eq_u32 vcc, -1, v15
s_cbranch_vccnz Lpretry_65
Lpdone_66:
v_add_f32 v72, v72, v76
v_add_f32 v80, v80, v84
v_add_f32 v73, v73, v77
v_add_f32 v81, v81, v85
v_add_f32 v74, v74, v78
v_add_f32 v82, v82, v86
v_add_f32 v75, v75, v79
v_add_f32 v83, v83, v87
v_add_f32 v72, v72, v80
v_add_f32 v74, v74, v82
v_add_f32 v73, v73, v81
v_add_f32 v75, v75, v83
v_permlane32_swap_b32 v72, v74
s_nop 0
v_permlane32_swap_b32 v73, v75
v_add_f32 v72, v72, v74
v_add_f32 v73, v73, v75
s_nop 1
v_permlane16_swap_b32 v72, v73
v_add_f32 v72, v72, v73
v_cvt_pk_bf16_f32 v72, v72, v72
v_and_b32 v72, 0xffff0000, v72
v_add_f32 v72, v72, v13
v_mov_b32 v73, v72
s_nop 1
v_permlane16_swap_b32 v72, v73
v_cvt_pk_bf16_f32 v72, v72, v73
s_mov_b32 exec_lo, 0xffff
s_mov_b32 exec_hi, 0xffff
s_cmp_eq_u32 s50, 1
s_cbranch_scc0 Lpl_67
buffer_store_dword v72, v12, s[40:43], s63 offen
Lpe_68:
s_mov_b64 exec, -1
Lw_63:
Lidle_50:
s_sub_u32 s55, s49, 18
s_lshl_b32 s55, s55, 2
s_add_u32 s55, s55, s3
s_mul_i32 s55, s55, 98304
s_lshl_b32 s56, s48, 10
s_add_u32 s55, s55, s56
v_lshrrev_b32 v10, 5, v0
v_lshlrev_b32 v10, 13, v10
v_and_b32 v11, 0x1ff, v1
v_add_u32 v10, v10, v11
buffer_load_dwordx4 v[124:127], v10, s[12:15], s55 offen
s_add_u32 s55, s55, 16384
buffer_load_dwordx4 v[124:127], v10, s[12:15], s55 offen
s_add_u32 s55, s55, 16384
buffer_load_dwordx4 v[124:127], v10, s[12:15], s55 offen
s_add_u32 s55, s55, 16384
buffer_load_dwordx4 v[124:127], v10, s[12:15], s55 offen
s_add_u32 s55, s55, 16384
buffer_load_dwordx4 v[124:127], v10, s[12:15], s55 offen
s_add_u32 s55, s55, 16384
buffer_load_dwordx4 v[124:127], v10, s[12:15], s55 offen
s_add_u32 s55, s53, 56320
s_mov_b64 exec, 1
s_mov_b32 s52, 0
Lpoll_69:
buffer_load_dword v11, v1, s[40:43], s55 offen sc1
s_waitcnt vmcnt(0)
v_cmp_eq_u32 vcc, -1, v11
s_cbranch_vccnz Lpretry_70
Lpdone_71:
s_mov_b64 exec, -1
s_cmp_ge_u32 s3, 2
s_cbranch_scc0 Lw_72
v_lshrrev_b32 v10, 1, v0
s_mov_b32 s55, 8192
v_mul_lo_u32 v10, v10, s55
v_and_b32 v15, 1, v0
v_lshl_add_u32 v10, v15, 4, v10
s_and_b32 s56, s3, 1
s_mul_i32 s56, s56, 2359296
s_lshl_b32 s57, s48, 10
s_add_u32 s56, s56, s57
s_lshl_b32 s57, s49, 5
s_add_u32 s56, s56, s57
s_mov_b32 s55, s56
buffer_load_dwordx4 v[72:75], v10, s[12:15], s55 offen
s_add_u32 s55, s55, 262144
buffer_load_dwordx4 v[76:79], v10, s[12:15], s55 offen
s_add_u32 s55, s55, 262144
buffer_load_dwordx4 v[80:83], v10, s[12:15], s55 offen
s_add_u32 s55, s55, 262144
buffer_load_dwordx4 v[84:87], v10, s[12:15], s55 offen
s_add_u32 s55, s55, 262144
buffer_load_dwordx4 v[88:91], v10, s[12:15], s55 offen
s_add_u32 s55, s55, 262144
buffer_load_dwordx4 v[92:95], v10, s[12:15], s55 offen
s_add_u32 s55, s55, 262144
buffer_load_dwordx4 v[96:99], v10, s[12:15], s55 offen
s_add_u32 s55, s55, 262144
buffer_load_dwordx4 v[100:103], v10, s[12:15], s55 offen
s_add_u32 s55, s55, 262144
buffer_load_dwordx4 v[104:107], v10, s[12:15], s55 offen
s_waitcnt vmcnt(0)
v_lshrrev_b32 v14, 4, v0
v_bfe_u32 v15, v0, 2, 2
v_lshl_add_u32 v14, v14, 3, v15
v_lshlrev_b32 v14, 5, v14
v_and_b32 v15, 3, v0
v_lshl_add_u32 v14, v15, 3, v14
s_lshl_b32 s55, s3, 11
s_add_u32 s55, s55, 155648
v_add_u32 v14, s55, v14
ds_write_b128 v4, v[72:75] offset:0
ds_write_b128 v4, v[76:79] offset:1024
ds_read_b64_tr_b16 v[72:73], v14 offset:0
ds_read_b64_tr_b16 v[74:75], v14 offset:128
ds_read_b64_tr_b16 v[76:77], v14 offset:1024
ds_read_b64_tr_b16 v[78:79], v14 offset:1152
ds_write_b128 v4, v[80:83] offset:0
ds_write_b128 v4, v[84:87] offset:1024
ds_read_b64_tr_b16 v[80:81], v14 offset:0
ds_read_b64_tr_b16 v[82:83], v14 offset:128
ds_read_b64_tr_b16 v[84:85], v14 offset:1024
ds_read_b64_tr_b16 v[86:87], v14 offset:1152
ds_write_b128 v4, v[88:91] offset:0
ds_write_b128 v4, v[92:95] offset:1024
ds_read_b64_tr_b16 v[88:89], v14 offset:0
ds_read_b64_tr_b16 v[90:91], v14 offset:128
ds_read_b64_tr_b16 v[92:93], v14 offset:1024
ds_read_b64_tr_b16 v[94:95], v14 offset:1152
ds_write_b128 v4, v[96:99] offset:0
ds_write_b128 v4, v[100:103] offset:1024
ds_read_b64_tr_b16 v[96:97], v14 offset:0
ds_read_b64_tr_b16 v[98:99], v14 offset:128
ds_read_b64_tr_b16 v[100:101], v14 offset:1024
ds_read_b64_tr_b16 v[102:103], v14 offset:1152
ds_write_b128 v4, v[104:107] offset:0
ds_read_b64_tr_b16 v[104:105], v14 offset:0
ds_read_b64_tr_b16 v[106:107], v14 offset:128
s_waitcnt lgkmcnt(0)
v_mov_b32 v120, 0x3f803f80
v_mov_b32 v121, 0x3f803f80
v_mov_b32 v122, 0x3f803f80
v_mov_b32 v123, 0x3f803f80
s_nop 1
v_mfma_f32_16x16x32_bf16 v[116:119], v[72:75], v[120:123], 0
v_mfma_f32_16x16x32_bf16 v[116:119], v[76:79], v[120:123], v[116:119]
v_mfma_f32_16x16x32_bf16 v[116:119], v[80:83], v[120:123], v[116:119]
v_mfma_f32_16x16x32_bf16 v[116:119], v[84:87], v[120:123], v[116:119]
v_mfma_f32_16x16x32_bf16 v[116:119], v[88:91], v[120:123], v[116:119]
v_mfma_f32_16x16x32_bf16 v[116:119], v[92:95], v[120:123], v[116:119]
v_mfma_f32_16x16x32_bf16 v[116:119], v[96:99], v[120:123], v[116:119]
v_mfma_f32_16x16x32_bf16 v[116:119], v[100:103], v[120:123], v[116:119]
v_mfma_f32_16x16x32_bf16 v[116:119], v[104:107], v[120:123], v[116:119]
Lw_72:
s_waitcnt vmcnt(0)
s_branch Lwq_51
Lffn_49:
v_mov_b32 v124, -1
v_mov_b32 v125, -1
v_mov_b32 v126, -1
v_mov_b32 v127, -1
s_mov_b64 exec, 0xffff
s_add_u32 s55, s68, 294912
buffer_store_dwordx4 v[124:127], v1, s[40:43], s55 offen sc1
s_add_u32 s55, s68, 442368
buffer_store_dwordx4 v[124:127], v1, s[40:43], s55 offen sc1
s_mov_b64 exec, -1
v_lshrrev_b32 v14, 4, v0
v_bfe_u32 v15, v0, 2, 2
v_lshl_add_u32 v14, v14, 3, v15
s_lshl_b32 s55, s3, 10
s_add_u32 s55, s55, 147456
v_add_u32 v110, s55, v1
s_lshl_b32 s55, s3, 11
s_add_u32 s55, s55, 147456
v_add_u32 v113, s55, v1
v_lshlrev_b32 v112, 7, v14
v_and_b32 v15, 3, v0
v_lshl_add_u32 v112, v15, 3, v112
s_lshl_b32 s55, s3, 5
s_add_u32 s55, s55, 147456
v_add_u32 v112, s55, v112
s_mul_i32 s57, s62, 9
s_sub_u32 s57, s49, s57
s_lshl_b32 s57, s57, 7
s_mul_i32 s55, s48, 663552
s_add_u32 s57, s57, s55
s_mul_i32 s55, s62, 331776
s_add_u32 s57, s57, s55
v_lshrrev_b32 v109, 3, v0
s_mov_b32 s55, 1152
v_mul_lo_u32 v109, v109, s55
v_and_b32 v15, 7, v0
v_lshl_add_u32 v109, v15, 4, v109
s_mul_i32 s55, s3, 9216
s_add_u32 s58, s57, s55
s_add_u32 s57, s58, s55
s_add_u32 s58, s58, 294912
s_add_u32 s98, s98, 73728
buffer_load_dwordx4 v[60:63], v9, s[20:23], s98 offen nt
s_add_u32 s98, s98, 516096
buffer_load_dwordx4 v[64:67], v9, s[20:23], s98 offen nt
s_add_u32 s98, s98, 73728
buffer_load_dwordx4 v[68:71], v9, s[20:23], s98 offen nt
s_add_u32 s98, s98, 516096
buffer_load_dwordx4 a[240:243], v9, s[20:23], s98 offen nt
s_add_u32 s98, s98, 73728
buffer_load_dwordx4 a[244:247], v9, s[20:23], s98 offen nt
s_add_u32 s98, s98, 516096
buffer_load_dwordx4 a[248:251], v9, s[20:23], s98 offen nt
s_add_u32 s98, s98, 73728
buffer_load_dwordx4 a[252:255], v9, s[20:23], s98 offen nt
s_waitcnt vmcnt(16)
ds_write_b128 v113, v[16:19] offset:8192
ds_write_b128 v113, v[20:23] offset:9216
s_waitcnt lgkmcnt(0)
s_barrier
ds_read_b64_tr_b16 v[16:17], v112 offset:8192
ds_read_b64_tr_b16 v[18:19], v112 offset:8704
ds_read_b64_tr_b16 v[20:21], v112 offset:12288
ds_read_b64_tr_b16 v[22:23], v112 offset:12800
s_waitcnt vmcnt(14)
ds_write_b128 v113, v[24:27] offset:0
ds_write_b128 v113, v[28:31] offset:1024
s_waitcnt lgkmcnt(0)
s_barrier
ds_read_b64_tr_b16 v[24:25], v112 offset:0
ds_read_b64_tr_b16 v[26:27], v112 offset:512
ds_read_b64_tr_b16 v[28:29], v112 offset:4096
ds_read_b64_tr_b16 v[30:31], v112 offset:4608
s_waitcnt vmcnt(12)
ds_write_b128 v113, v[32:35] offset:8192
ds_write_b128 v113, v[36:39] offset:9216
s_waitcnt lgkmcnt(0)
s_barrier
ds_read_b64_tr_b16 v[32:33], v112 offset:8192
ds_read_b64_tr_b16 v[34:35], v112 offset:8704
ds_read_b64_tr_b16 v[36:37], v112 offset:12288
ds_read_b64_tr_b16 v[38:39], v112 offset:12800
s_waitcnt vmcnt(10)
ds_write_b128 v113, v[40:43] offset:0
ds_write_b128 v113, v[44:47] offset:1024
buffer_load_dwordx4 v[72:75], v109, s[28:31], s57 offen nt
s_add_u32 s57, s57, 9216
buffer_load_dwordx4 v[76:79], v109, s[28:31], s57 offen nt
s_waitcnt lgkmcnt(0)
s_barrier
ds_read_b64_tr_b16 v[40:41], v112 offset:0
ds_read_b64_tr_b16 v[42:43], v112 offset:512
ds_read_b64_tr_b16 v[44:45], v112 offset:4096
ds_read_b64_tr_b16 v[46:47], v112 offset:4608
s_waitcnt vmcnt(10)
ds_write_b128 v113, v[48:51] offset:8192
ds_write_b128 v113, v[52:55] offset:9216
s_add_u32 s57, s57, 64512
buffer_load_dwordx4 v[80:83], v109, s[28:31], s57 offen nt
s_add_u32 s57, s57, 9216
buffer_load_dwordx4 v[84:87], v109, s[28:31], s57 offen nt
s_waitcnt lgkmcnt(0)
s_barrier
ds_read_b64_tr_b16 v[48:49], v112 offset:8192
ds_read_b64_tr_b16 v[50:51], v112 offset:8704
ds_read_b64_tr_b16 v[52:53], v112 offset:12288
ds_read_b64_tr_b16 v[54:55], v112 offset:12800
s_waitcnt vmcnt(10)
ds_write_b128 v113, v[56:59] offset:0
ds_write_b128 v113, v[60:63] offset:1024
s_add_u32 s57, s57, 64512
buffer_load_dwordx4 v[88:91], v109, s[28:31], s57 offen nt
s_add_u32 s57, s57, 9216
buffer_load_dwordx4 v[92:95], v109, s[28:31], s57 offen nt
s_waitcnt lgkmcnt(0)
s_barrier
ds_read_b64_tr_b16 v[56:57], v112 offset:0
ds_read_b64_tr_b16 v[58:59], v112 offset:512
ds_read_b64_tr_b16 v[60:61], v112 offset:4096
ds_read_b64_tr_b16 v[62:63], v112 offset:4608
s_waitcnt vmcnt(10)
ds_write_b128 v113, v[64:67] offset:8192
ds_write_b128 v113, v[68:71] offset:9216
s_add_u32 s57, s57, 64512
buffer_load_dwordx4 v[96:99], v109, s[28:31], s57 offen nt
s_add_u32 s57, s57, 9216
buffer_load_dwordx4 v[100:103], v109, s[28:31], s57 offen nt
s_waitcnt lgkmcnt(0)
s_barrier
ds_read_b64_tr_b16 v[64:65], v112 offset:8192
ds_read_b64_tr_b16 v[66:67], v112 offset:8704
ds_read_b64_tr_b16 v[68:69], v112 offset:12288
ds_read_b64_tr_b16 v[70:71], v112 offset:12800
s_waitcnt vmcnt(10)
ds_write_b128 v113, a[240:243] offset:0
ds_write_b128 v113, a[244:247] offset:1024
buffer_load_dwordx4 v[104:107], v109, s[28:31], s58 offen nt
s_waitcnt lgkmcnt(0)
s_barrier
ds_read_b64_tr_b16 a[240:241], v112 offset:0
ds_read_b64_tr_b16 a[242:243], v112 offset:512
ds_read_b64_tr_b16 a[244:245], v112 offset:4096
ds_read_b64_tr_b16 a[246:247], v112 offset:4608
s_waitcnt vmcnt(9)
ds_write_b128 v113, a[248:251] offset:8192
ds_write_b128 v113, a[252:255] offset:9216
s_waitcnt lgkmcnt(0)
s_barrier
ds_read_b64_tr_b16 a[248:249], v112 offset:8192
ds_read_b64_tr_b16 a[250:251], v112 offset:8704
ds_read_b64_tr_b16 a[252:253], v112 offset:12288
ds_read_b64_tr_b16 a[254:255], v112 offset:12800
s_waitcnt lgkmcnt(0)
v_mov_b32 v116, 0x3f803f80
v_mov_b32 v117, 0x3f803f80
v_mov_b32 v118, 0x3f803f80
v_mov_b32 v119, 0x3f803f80
s_nop 1
v_mfma_f32_16x16x32_bf16 v[6:9], v[16:19], v[116:119], 0
v_mfma_f32_16x16x32_bf16 v[6:9], v[20:23], v[116:119], v[6:9]
v_mfma_f32_16x16x32_bf16 v[6:9], v[24:27], v[116:119], v[6:9]
v_mfma_f32_16x16x32_bf16 v[6:9], v[28:31], v[116:119], v[6:9]
v_mfma_f32_16x16x32_bf16 v[6:9], v[32:35], v[116:119], v[6:9]
v_mfma_f32_16x16x32_bf16 v[6:9], v[36:39], v[116:119], v[6:9]
v_mfma_f32_16x16x32_bf16 v[6:9], v[40:43], v[116:119], v[6:9]
v_mfma_f32_16x16x32_bf16 v[6:9], v[44:47], v[116:119], v[6:9]
v_mfma_f32_16x16x32_bf16 v[6:9], v[48:51], v[116:119], v[6:9]
v_mfma_f32_16x16x32_bf16 v[6:9], v[52:55], v[116:119], v[6:9]
v_mfma_f32_16x16x32_bf16 v[6:9], v[56:59], v[116:119], v[6:9]
v_mfma_f32_16x16x32_bf16 v[6:9], v[60:63], v[116:119], v[6:9]
v_mfma_f32_16x16x32_bf16 v[6:9], v[64:67], v[116:119], v[6:9]
v_mfma_f32_16x16x32_bf16 v[6:9], v[68:71], v[116:119], v[6:9]
v_mfma_f32_16x16x32_bf16 v[6:9], a[240:243], v[116:119], v[6:9]
v_mfma_f32_16x16x32_bf16 v[6:9], a[244:247], v[116:119], v[6:9]
v_mfma_f32_16x16x32_bf16 v[6:9], a[248:251], v[116:119], v[6:9]
v_mfma_f32_16x16x32_bf16 v[6:9], a[252:255], v[116:119], v[6:9]
s_waitcnt vmcnt(7)
ds_write_b128 v113, v[72:75] offset:0
ds_write_b128 v113, v[76:79] offset:1024
s_waitcnt lgkmcnt(0)
s_barrier
ds_read_b64_tr_b16 v[72:73], v112 offset:0
ds_read_b64_tr_b16 v[74:75], v112 offset:512
ds_read_b64_tr_b16 v[76:77], v112 offset:4096
ds_read_b64_tr_b16 v[78:79], v112 offset:4608
s_waitcnt vmcnt(5)
ds_write_b128 v113, v[80:83] offset:8192
ds_write_b128 v113, v[84:87] offset:9216
s_waitcnt lgkmcnt(0)
s_barrier
ds_read_b64_tr_b16 v[80:81], v112 offset:8192
ds_read_b64_tr_b16 v[82:83], v112 offset:8704
ds_read_b64_tr_b16 v[84:85], v112 offset:12288
ds_read_b64_tr_b16 v[86:87], v112 offset:12800
s_waitcnt vmcnt(3)
ds_write_b128 v113, v[88:91] offset:0
ds_write_b128 v113, v[92:95] offset:1024
s_waitcnt lgkmcnt(0)
s_barrier
ds_read_b64_tr_b16 v[88:89], v112 offset:0
ds_read_b64_tr_b16 v[90:91], v112 offset:512
ds_read_b64_tr_b16 v[92:93], v112 offset:4096
ds_read_b64_tr_b16 v[94:95], v112 offset:4608
s_waitcnt vmcnt(1)
ds_write_b128 v113, v[96:99] offset:8192
ds_write_b128 v113, v[100:103] offset:9216
s_waitcnt lgkmcnt(0)
s_barrier
ds_read_b64_tr_b16 v[96:97], v112 offset:8192
ds_read_b64_tr_b16 v[98:99], v112 offset:8704
ds_read_b64_tr_b16 v[100:101], v112 offset:12288
ds_read_b64_tr_b16 v[102:103], v112 offset:12800
s_waitcnt vmcnt(0)
ds_write_b128 v110, v[104:107] offset:0
s_waitcnt lgkmcnt(0)
s_barrier
ds_read_b64_tr_b16 v[104:105], v112 offset:0
ds_read_b64_tr_b16 v[106:107], v112 offset:512
s_waitcnt lgkmcnt(0)
s_barrier
v_bfe_u32 v127, v0, 2, 1
v_lshl_add_u32 v127, v127, 8, v3
v_lshlrev_b32 v126, 3, v0
v_add_u32 v126, 152064, v126
v_and_b32 v4, 3, v0
v_lshlrev_b32 v4, 4, v4
v_bfe_u32 v13, v0, 4, 1
v_lshl_add_u32 v4, v13, 3, v4
v_lshrrev_b32 v13, 5, v0
v_lshl_add_u32 v4, v13, 6, v4
s_lshl_b32 s63, s49, 9
s_lshl_b32 s56, s3, 7
s_add_u32 s63, s63, s56
s_add_u32 s63, s63, s53
s_add_u32 s63, s63, 51712
s_lshl_b32 s55, s3, 10
s_add_u32 s55, s55, 147456
v_add_u32 v11, s55, v1
s_lshl_b32 s55, s3, 5
s_add_u32 s55, s55, 152064
v_lshl_add_u32 v5, v0, 3, s55
v_mov_b32 v12, 0
v_mov_b32 v13, 0
v_mov_b32 v14, 0x3f803f80
s_add_u32 s55, s69, 37888
s_cmp_eq_u32 s3, 0
s_cbranch_scc0 Lg1_73
v_and_b32 v10, 0x1ff, v1
s_add_u32 s56, s55, 4096
s_mov_b32 s52, 0
Lpoll_75:
buffer_load_dwordx4 v[108:111], v1, s[40:43], s55 offen sc1
buffer_load_dwordx4 v[112:115], v10, s[40:43], s56 offen sc1
s_waitcnt vmcnt(0)
v_max3_u32 v15, v108, v109, v110
v_max3_u32 v15, v15, v111, v112
v_max3_u32 v15, v15, v113, v114
v_max_u32 v15, v15, v115
v_cmp_eq_u32 vcc, -1, v15
s_cbranch_vccnz Lpretry_76
Lpdone_77:
s_branch Lgd_74
Lg1_73:
s_mov_b32 s52, 0
Lpoll_78:
buffer_load_dwordx4 v[108:111], v1, s[40:43], s55 offen sc1
s_waitcnt vmcnt(0)
v_max3_u32 v15, v108, v109, v110
v_max_u32 v15, v15, v111
v_cmp_eq_u32 vcc, -1, v15
s_cbranch_vccnz Lpretry_79
Lpdone_80:
Lgd_74:
ds_write_b128 v11, v[108:111]
v_dot2c_f32_bf16 v12, v108, v14
v_dot2c_f32_bf16 v13, v108, v108
v_dot2c_f32_bf16 v12, v109, v14
v_dot2c_f32_bf16 v13, v109, v109
v_dot2c_f32_bf16 v12, v110, v14
v_dot2c_f32_bf16 v13, v110, v110
v_dot2c_f32_bf16 v12, v111, v14
v_dot2c_f32_bf16 v13, v111, v111
s_cmp_eq_u32 s3, 0
s_cbranch_scc0 Lw_81
s_mov_b32 exec_hi, 0
ds_write_b128 v11, v[112:115] offset:4096
v_dot2c_f32_bf16 v12, v112, v14
v_dot2c_f32_bf16 v13, v112, v112
v_dot2c_f32_bf16 v12, v113, v14
v_dot2c_f32_bf16 v13, v113, v113
v_dot2c_f32_bf16 v12, v114, v14
v_dot2c_f32_bf16 v13, v114, v114
v_dot2c_f32_bf16 v12, v115, v14
v_dot2c_f32_bf16 v13, v115, v115
s_mov_b64 exec, -1
Lw_81:
s_nop 0
v_add_f32_dpp v12, v12, v12 row_ror:4 row_mask:0xf bank_mask:0xf
v_add_f32_dpp v13, v13, v13 row_ror:4 row_mask:0xf bank_mask:0xf
s_nop 0
v_add_f32_dpp v12, v12, v12 row_ror:8 row_mask:0xf bank_mask:0xf
v_add_f32_dpp v13, v13, v13 row_ror:8 row_mask:0xf bank_mask:0xf
s_mov_b64 exec, s[96:97]
ds_write_b64 v5, v[12:13]
s_mov_b64 exec, -1
s_waitcnt lgkmcnt(0)
s_barrier
ds_read_b64 v[10:11], v126
v_mov_b32 v5, v127
ds_read_b128 v[108:111], v5 offset:0
ds_read_b128 v[112:115], v5 offset:512
ds_read_b128 v[116:119], v5 offset:1024
s_waitcnt lgkmcnt(2)
v_mfma_f32_16x16x32_bf16 v[120:123], v[16:19], v[108:111], 0
v_add_f32_dpp v10, v10, v10 row_ror:4 row_mask:0xf bank_mask:0xf
v_add_f32_dpp v11, v11, v11 row_ror:4 row_mask:0xf bank_mask:0xf
s_nop 0
v_add_f32_dpp v10, v10, v10 row_ror:8 row_mask:0xf bank_mask:0xf
v_add_f32_dpp v11, v11, v11 row_ror:8 row_mask:0xf bank_mask:0xf
v_mfma_f32_16x16x32_bf16 v[124:127], v[20:23], v[108:111], 0
s_nop 0
v_permlane32_swap_b32 v10, v11
v_add_f32 v10, v10, v11
ds_read_b128 v[108:111], v5 offset:1536
s_waitcnt lgkmcnt(2)
v_mfma_f32_16x16x32_bf16 v[120:123], v[24:27], v[112:115], v[120:123]
v_mov_b32 v11, v10
s_nop 1
v_permlane16_swap_b32 v10, v11
v_mfma_f32_16x16x32_bf16 v[124:127], v[28:31], v[112:115], v[124:127]
v_add_f32 v10, v10, v11
v_mov_b32 v11, v10
ds_read_b128 v[112:115], v5 offset:2048
s_waitcnt lgkmcnt(2)
v_mfma_f32_16x16x32_bf16 v[120:123], v[32:35], v[116:119], v[120:123]
v_permlane32_swap_b32 v10, v11
v_mul_f32 v10, 0x3ae38e39, v10
v_mfma_f32_16x16x32_bf16 v[124:127], v[36:39], v[116:119], v[124:127]
v_mul_f32 v11, 0x3ae38e39, v11
v_fma_f32 v11, -v10, v10, v11
ds_read_b128 v[116:119], v5 offset:2560
s_waitcnt lgkmcnt(2)
v_mfma_f32_16x16x32_bf16 v[120:123], v[40:43], v[108:111], v[120:123]
v_max_f32 v11, 0, v11
v_add_f32 v11, 0x3727c5ac, v11
v_mfma_f32_16x16x32_bf16 v[124:127], v[44:47], v[108:111], v[124:127]
v_rsq_f32 v11, v11
v_mul_f32 v12, v10, v6
ds_read_b128 v[108:111], v5 offset:3072
s_waitcnt lgkmcnt(2)
v_mfma_f32_16x16x32_bf16 v[120:123], v[48:51], v[112:115], v[120:123]
v_mul_f32 v13, v10, v7
v_mul_f32 v14, v10, v8
v_mfma_f32_16x16x32_bf16 v[124:127], v[52:55], v[112:115], v[124:127]
v_mul_f32 v15, v10, v9
ds_read_b128 v[112:115], v5 offset:3584
s_waitcnt lgkmcnt(2)
v_mfma_f32_16x16x32_bf16 v[120:123], v[56:59], v[116:119], v[120:123]
v_mfma_f32_16x16x32_bf16 v[124:127], v[60:63], v[116:119], v[124:127]
ds_read_b128 v[116:119], v5 offset:4096
s_waitcnt lgkmcnt(2)
v_mfma_f32_16x16x32_bf16 v[120:123], v[64:67], v[108:111], v[120:123]
v_mfma_f32_16x16x32_bf16 v[124:127], v[68:71], v[108:111], v[124:127]
s_waitcnt lgkmcnt(1)
v_mfma_f32_16x16x32_bf16 v[120:123], a[240:243], v[112:115], v[120:123]
v_mfma_f32_16x16x32_bf16 v[124:127], a[244:247], v[112:115], v[124:127]
s_waitcnt lgkmcnt(0)
v_mfma_f32_16x16x32_bf16 v[120:123], a[248:251], v[116:119], v[120:123]
v_mfma_f32_16x16x32_bf16 v[124:127], a[252:255], v[116:119], v[124:127]
s_nop 7
v_add_f32_dpp v120, v124, v120 row_shl:4 row_mask:0xf bank_mask:0xf
v_add_f32_dpp v121, v125, v121 row_shl:4 row_mask:0xf bank_mask:0xf
v_add_f32_dpp v122, v126, v122 row_shl:4 row_mask:0xf bank_mask:0xf
v_add_f32_dpp v123, v127, v123 row_shl:4 row_mask:0xf bank_mask:0xf
v_sub_f32 v120, v120, v12
v_sub_f32 v121, v121, v13
v_sub_f32 v122, v122, v14
v_sub_f32 v123, v123, v15
v_mul_f32 v120, v11, v120
v_mul_f32 v121, v11, v121
v_mul_f32 v122, v11, v122
v_mul_f32 v123, v11, v123
s_cmp_eq_u32 s62, 0
s_cbranch_scc0 Lup_82
v_mul_f32 v124, 0xbfb8aa3b, v120
v_mul_f32 v125, 0xbfb8aa3b, v121
v_mul_f32 v126, 0xbfb8aa3b, v122
v_mul_f32 v127, 0xbfb8aa3b, v123
v_exp_f32 v124, v124
v_exp_f32 v125, v125
v_exp_f32 v126, v126
v_exp_f32 v127, v127
v_add_f32 v124, 1.0, v124
v_add_f32 v125, 1.0, v125
v_add_f32 v126, 1.0, v126
v_add_f32 v127, 1.0, v127
v_rcp_f32 v124, v124
v_rcp_f32 v125, v125
v_rcp_f32 v126, v126
v_rcp_f32 v127, v127
v_mul_f32 v120, v120, v124
v_mul_f32 v121, v121, v125
v_mul_f32 v122, v122, v126
v_mul_f32 v123, v123, v127
Lup_82:
v_cvt_pk_bf16_f32 v120, v120, v121
v_cvt_pk_bf16_f32 v121, v122, v123
s_mov_b64 exec, s[96:97]
s_cmp_eq_u32 s50, 1
s_cbranch_scc0 Lpl_83
buffer_store_dwordx2 v[120:121], v4, s[40:43], s63 offen
Lpe_84:
s_mov_b64 exec, -1
s_lshl_b32 s56, s3, 11
s_add_u32 s56, s56, 155648
v_add_u32 v4, s56, v1
s_lshl_b32 s61, s49, 1
s_add_u32 s61, s61, s3
s_cmp_lt_u32 s3, 2
s_cbranch_scc0 Lw_85
v_mov_b32 v13, 0
v_lshrrev_b32 v10, 4, v0
v_bfe_u32 v11, v0, 2, 2
v_and_b32 v14, 3, v0
v_lshlrev_b32 v12, 4, v14
v_and_b32 v15, 1, v11
v_lshl_add_u32 v12, v15, 3, v12
v_lshrrev_b32 v15, 1, v11
v_lshl_add_u32 v12, v15, 6, v12
v_lshl_add_u32 v5, v10, 1, v12
s_lshl_b32 s55, s61, 7
s_add_u32 s55, s55, s53
s_add_u32 s55, s55, 37888
buffer_load_short_d16_hi v13, v5, s[40:43], s55 offen sc1
v_lshrrev_b32 v10, 5, v0
v_lshl_add_u32 v12, v10, 2, v12
s_lshl_b32 s63, s61, 7
s_add_u32 s63, s63, s53
s_add_u32 s63, s63, 42496
Lw_85:
s_mul_i32 s55, s62, 2304
s_add_u32 s55, s55, s69
s_add_u32 s55, s55, 51712
s_lshl_b32 s56, s3, 10
s_add_u32 s56, s56, 147456
v_add_u32 v10, s56, v1
v_bfe_u32 v5, v0, 2, 1
v_lshl_add_u32 v5, v5, 8, v3
v_lshrrev_b32 v11, 4, v0
v_lshlrev_b32 v11, 6, v11
v_and_b32 v14, 3, v0
v_lshl_add_u32 v11, v14, 4, v11
s_add_u32 s58, s68, 147456
s_barrier
s_cmp_eq_u32 s3, 3
s_cbranch_scc1 Lh3_86
s_cmp_eq_u32 s3, 2
s_cbranch_scc0 Lh2_87
s_mov_b64 exec, 0xffff
Lh2_87:
s_add_u32 s56, s55, 4608
s_mov_b32 s52, 0
Lpoll_88:
buffer_load_dwordx4 v[108:111], v1, s[40:43], s55 offen sc1
buffer_load_dwordx4 v[112:115], v1, s[40:43], s56 offen sc1
s_waitcnt vmcnt(0)
v_max3_u32 v15, v108, v110, v112
v_max_u32 v15, v15, v114
v_cmp_eq_u32 vcc, -1, v15
s_cbranch_vccnz Lpretry_89
Lpdone_90:
v_and_b32 v116, 0xffff, v112
v_and_b32 v117, 0xffff, v113
v_and_b32 v118, 0xffff, v114
v_and_b32 v119, 0xffff, v115
v_and_b32 v112, 0xffff0000, v112
v_and_b32 v113, 0xffff0000, v113
v_and_b32 v114, 0xffff0000, v114
v_and_b32 v115, 0xffff0000, v115
v_dot2_f32_bf16 v116, v108, v116, 0
v_dot2_f32_bf16 v117, v109, v117, 0
v_dot2_f32_bf16 v118, v110, v118, 0
v_dot2_f32_bf16 v119, v111, v119, 0
v_dot2_f32_bf16 v112, v108, v112, 0
v_dot2_f32_bf16 v113, v109, v113, 0
v_dot2_f32_bf16 v114, v110, v114, 0
v_dot2_f32_bf16 v115, v111, v115, 0
v_cvt_pk_bf16_f32 v108, v116, v112
v_cvt_pk_bf16_f32 v109, v117, v113
v_cvt_pk_bf16_f32 v110, v118, v114
v_cvt_pk_bf16_f32 v111, v119, v115
ds_write_b128 v10, v[108:111]
s_mov_b64 exec, -1
s_waitcnt lgkmcnt(0)
Lh3_86:
s_barrier
ds_read_b128 v[108:111], v5 offset:0
ds_read_b128 v[112:115], v5 offset:512
ds_read_b128 v[116:119], v5 offset:1024
s_waitcnt lgkmcnt(2)
v_mfma_f32_16x16x32_bf16 v[120:123], v[72:75], v[108:111], 0
v_mfma_f32_16x16x32_bf16 v[124:127], v[76:79], v[108:111], 0
ds_read_b128 v[108:111], v5 offset:1536
s_waitcnt lgkmcnt(2)
v_mfma_f32_16x16x32_bf16 v[120:123], v[80:83], v[112:115], v[120:123]
v_mfma_f32_16x16x32_bf16 v[124:127], v[84:87], v[112:115], v[124:127]
ds_read_b128 v[112:115], v5 offset:2048
s_waitcnt lgkmcnt(2)
v_mfma_f32_16x16x32_bf16 v[120:123], v[88:91], v[116:119], v[120:123]
v_mfma_f32_16x16x32_bf16 v[124:127], v[92:95], v[116:119], v[124:127]
s_waitcnt lgkmcnt(1)
v_mfma_f32_16x16x32_bf16 v[120:123], v[96:99], v[108:111], v[120:123]
v_mfma_f32_16x16x32_bf16 v[124:127], v[100:103], v[108:111], v[124:127]
s_waitcnt lgkmcnt(0)
v_mfma_f32_16x16x32_bf16 v[120:123], v[104:107], v[112:115], v[120:123]
s_nop 7
v_add_f32_dpp v120, v124, v120 row_shl:4 row_mask:0xf bank_mask:0xf
v_add_f32_dpp v121, v125, v121 row_shl:4 row_mask:0xf bank_mask:0xf
v_add_f32_dpp v122, v126, v122 row_shl:4 row_mask:0xf bank_mask:0xf
v_add_f32_dpp v123, v127, v123 row_shl:4 row_mask:0xf bank_mask:0xf
s_mov_b64 exec, s[96:97]
buffer_store_dwordx4 v[120:123], v11, s[40:43], s58 offen sc1
s_mov_b64 exec, -1
s_cmp_ge_u32 s3, 2
s_cbranch_scc1 Lffn_91
s_lshl_b32 s55, s61, 12
s_add_u32 s55, s55, 737280
s_waitcnt vmcnt(0)
s_mov_b32 s52, 0
Lpoll_93:
buffer_load_dwordx4 v[72:75], v1, s[40:43], s55 offen offset:0 sc1
buffer_load_dwordx4 v[76:79], v1, s[40:43], s55 offen offset:1024 sc1
buffer_load_dwordx4 v[80:83], v1, s[40:43], s55 offen offset:2048 sc1
buffer_load_dwordx4 v[84:87], v1, s[40:43], s55 offen offset:3072 sc1
s_waitcnt vmcnt(0)
v_max3_u32 v15, v72, v76, v80
v_max_u32 v15, v15, v84
v_cmp_eq_u32 vcc, -1, v15
s_cbranch_vccnz Lpretry_94
Lpdone_95:
v_add_f32 v72, v72, v76
v_add_f32 v80, v80, v84
v_add_f32 v73, v73, v77
v_add_f32 v81, v81, v85
v_add_f32 v74, v74, v78
v_add_f32 v82, v82, v86
v_add_f32 v75, v75, v79
v_add_f32 v83, v83, v87
v_add_f32 v72, v72, v80
v_add_f32 v74, v74, v82
v_add_f32 v73, v73, v81
v_add_f32 v75, v75, v83
v_permlane32_swap_b32 v72, v74
s_nop 0
v_permlane32_swap_b32 v73, v75
v_add_f32 v72, v72, v74
v_add_f32 v73, v73, v75
s_nop 1
v_permlane16_swap_b32 v72, v73
v_add_f32 v72, v72, v73
v_cvt_pk_bf16_f32 v72, v72, v72
v_and_b32 v72, 0xffff0000, v72
v_add_f32 v72, v72, v13
v_mov_b32 v73, v72
s_nop 1
v_permlane16_swap_b32 v72, v73
v_cvt_pk_bf16_f32 v72, v72, v73
s_mov_b32 exec_lo, 0xffff
s_mov_b32 exec_hi, 0xffff
s_cmp_eq_u32 s50, 1
s_cbranch_scc0 Lpl_96
buffer_store_dword v72, v12, s[40:43], s63 offen
Lpe_97:
s_mov_b64 exec, -1
s_branch Lffr_92
Lffn_91:
v_lshrrev_b32 v10, 1, v0
s_mov_b32 s55, 8192
v_mul_lo_u32 v10, v10, s55
v_and_b32 v15, 1, v0
v_lshl_add_u32 v10, v15, 4, v10
s_and_b32 s56, s3, 1
s_mul_i32 s56, s56, 2359296
s_lshl_b32 s57, s48, 10
s_add_u32 s56, s56, s57
s_lshl_b32 s57, s49, 5
s_add_u32 s56, s56, s57
s_mov_b32 s55, s56
buffer_load_dwordx4 v[72:75], v10, s[12:15], s55 offen
s_add_u32 s55, s55, 262144
buffer_load_dwordx4 v[76:79], v10, s[12:15], s55 offen
s_add_u32 s55, s55, 262144
buffer_load_dwordx4 v[80:83], v10, s[12:15], s55 offen
s_add_u32 s55, s55, 262144
buffer_load_dwordx4 v[84:87], v10, s[12:15], s55 offen
s_add_u32 s55, s55, 262144
buffer_load_dwordx4 v[88:91], v10, s[12:15], s55 offen
s_add_u32 s55, s55, 262144
buffer_load_dwordx4 v[92:95], v10, s[12:15], s55 offen
s_add_u32 s55, s55, 262144
buffer_load_dwordx4 v[96:99], v10, s[12:15], s55 offen
s_add_u32 s55, s55, 262144
buffer_load_dwordx4 v[100:103], v10, s[12:15], s55 offen
s_add_u32 s55, s55, 262144
buffer_load_dwordx4 v[104:107], v10, s[12:15], s55 offen
s_waitcnt vmcnt(0)
v_lshrrev_b32 v14, 4, v0
v_bfe_u32 v15, v0, 2, 2
v_lshl_add_u32 v14, v14, 3, v15
v_lshlrev_b32 v14, 5, v14
v_and_b32 v15, 3, v0
v_lshl_add_u32 v14, v15, 3, v14
s_lshl_b32 s55, s3, 11
s_add_u32 s55, s55, 155648
v_add_u32 v14, s55, v14
ds_write_b128 v4, v[72:75] offset:0
ds_write_b128 v4, v[76:79] offset:1024
ds_read_b64_tr_b16 v[72:73], v14 offset:0
ds_read_b64_tr_b16 v[74:75], v14 offset:128
ds_read_b64_tr_b16 v[76:77], v14 offset:1024
ds_read_b64_tr_b16 v[78:79], v14 offset:1152
ds_write_b128 v4, v[80:83] offset:0
ds_write_b128 v4, v[84:87] offset:1024
ds_read_b64_tr_b16 v[80:81], v14 offset:0
ds_read_b64_tr_b16 v[82:83], v14 offset:128
ds_read_b64_tr_b16 v[84:85], v14 offset:1024
ds_read_b64_tr_b16 v[86:87], v14 offset:1152
ds_write_b128 v4, v[88:91] offset:0
ds_write_b128 v4, v[92:95] offset:1024
ds_read_b64_tr_b16 v[88:89], v14 offset:0
ds_read_b64_tr_b16 v[90:91], v14 offset:128
ds_read_b64_tr_b16 v[92:93], v14 offset:1024
ds_read_b64_tr_b16 v[94:95], v14 offset:1152
ds_write_b128 v4, v[96:99] offset:0
ds_write_b128 v4, v[100:103] offset:1024
ds_read_b64_tr_b16 v[96:97], v14 offset:0
ds_read_b64_tr_b16 v[98:99], v14 offset:128
ds_read_b64_tr_b16 v[100:101], v14 offset:1024
ds_read_b64_tr_b16 v[102:103], v14 offset:1152
ds_write_b128 v4, v[104:107] offset:0
ds_read_b64_tr_b16 v[104:105], v14 offset:0
ds_read_b64_tr_b16 v[106:107], v14 offset:128
s_waitcnt lgkmcnt(0)
v_mov_b32 v120, 0x3f803f80
v_mov_b32 v121, 0x3f803f80
v_mov_b32 v122, 0x3f803f80
v_mov_b32 v123, 0x3f803f80
s_nop 1
v_mfma_f32_16x16x32_bf16 v[116:119], v[72:75], v[120:123], 0
v_mfma_f32_16x16x32_bf16 v[116:119], v[76:79], v[120:123], v[116:119]
v_mfma_f32_16x16x32_bf16 v[116:119], v[80:83], v[120:123], v[116:119]
v_mfma_f32_16x16x32_bf16 v[116:119], v[84:87], v[120:123], v[116:119]
v_mfma_f32_16x16x32_bf16 v[116:119], v[88:91], v[120:123], v[116:119]
v_mfma_f32_16x16x32_bf16 v[116:119], v[92:95], v[120:123], v[116:119]
v_mfma_f32_16x16x32_bf16 v[116:119], v[96:99], v[120:123], v[116:119]
v_mfma_f32_16x16x32_bf16 v[116:119], v[100:103], v[120:123], v[116:119]
v_mfma_f32_16x16x32_bf16 v[116:119], v[104:107], v[120:123], v[116:119]
Lffr_92:
Lwq_51:
s_cmp_eq_u32 s3, 3
s_cbranch_scc0 Lw_98
s_nop 5
ds_write_b128 v4, v[116:119] offset:1024
s_waitcnt lgkmcnt(0)
Lw_98:
s_barrier
s_cmp_ge_u32 s3, 2
s_cbranch_scc0 Lw_99
ds_read_b128 v[108:111], v4 offset:3072
s_and_b32 s55, s3, 1
s_mul_i32 s55, s55, 2304
v_bfe_u32 v126, v0, 2, 1
v_lshl_add_u32 v126, v126, 8, v3
v_add_u32 v126, s55, v126
v_lshrrev_b32 v12, 5, v0
s_and_b32 s55, s49, 7
s_lshl_b32 s55, s55, 1
v_add_u32 v12, s55, v12
v_and_b32 v13, 3, v12
v_lshlrev_b32 v13, 7, v13
v_lshrrev_b32 v12, 2, v12
v_lshl_add_u32 v13, v12, 5, v13
v_bfe_u32 v12, v0, 4, 1
v_lshl_add_u32 v13, v12, 3, v13
v_and_b32 v12, 3, v0
v_lshl_add_u32 v13, v12, 10, v13
v_mov_b32 v127, v13
s_add_u32 s63, s65, 0
v_lshlrev_b32 v125, 3, v0
v_add_u32 v125, 152064, v125
s_waitcnt lgkmcnt(0)
v_add_f32 v116, v116, v108
v_add_f32 v117, v117, v109
v_add_f32 v118, v118, v110
v_add_f32 v119, v119, v111
Lw_99:
s_lshl_b32 s55, s3, 10
s_add_u32 s55, s55, 147456
v_add_u32 v11, s55, v1
s_lshl_b32 s55, s3, 5
s_add_u32 s55, s55, 152064
v_lshl_add_u32 v5, v0, 3, s55
v_mov_b32 v12, 0
v_mov_b32 v13, 0
v_mov_b32 v14, 0x3f803f80
s_add_u32 s55, s69, 42496
s_cmp_eq_u32 s3, 0
s_cbranch_scc0 Lg1_100
v_and_b32 v10, 0x1ff, v1
s_add_u32 s56, s55, 4096
s_mov_b32 s52, 0
Lpoll_102:
buffer_load_dwordx4 v[108:111], v1, s[40:43], s55 offen sc1
buffer_load_dwordx4 v[112:115], v10, s[40:43], s56 offen sc1
s_waitcnt vmcnt(0)
v_max3_u32 v15, v108, v109, v110
v_max3_u32 v15, v15, v111, v112
v_max3_u32 v15, v15, v113, v114
v_max_u32 v15, v15, v115
v_cmp_eq_u32 vcc, -1, v15
s_cbranch_vccnz Lpretry_103
Lpdone_104:
s_branch Lgd_101
Lg1_100:
s_mov_b32 s52, 0
Lpoll_105:
buffer_load_dwordx4 v[108:111], v1, s[40:43], s55 offen sc1
s_waitcnt vmcnt(0)
v_max3_u32 v15, v108, v109, v110
v_max_u32 v15, v15, v111
v_cmp_eq_u32 vcc, -1, v15
s_cbranch_vccnz Lpretry_106
Lpdone_107:
Lgd_101:
ds_write_b128 v11, v[108:111]
v_dot2c_f32_bf16 v12, v108, v14
v_dot2c_f32_bf16 v13, v108, v108
v_dot2c_f32_bf16 v12, v109, v14
v_dot2c_f32_bf16 v13, v109, v109
v_dot2c_f32_bf16 v12, v110, v14
v_dot2c_f32_bf16 v13, v110, v110
v_dot2c_f32_bf16 v12, v111, v14
v_dot2c_f32_bf16 v13, v111, v111
s_cmp_eq_u32 s3, 0
s_cbranch_scc0 Lw_108
s_mov_b32 exec_hi, 0
ds_write_b128 v11, v[112:115] offset:4096
v_dot2c_f32_bf16 v12, v112, v14
v_dot2c_f32_bf16 v13, v112, v112
v_dot2c_f32_bf16 v12, v113, v14
v_dot2c_f32_bf16 v13, v113, v113
v_dot2c_f32_bf16 v12, v114, v14
v_dot2c_f32_bf16 v13, v114, v114
v_dot2c_f32_bf16 v12, v115, v14
v_dot2c_f32_bf16 v13, v115, v115
s_mov_b64 exec, -1
Lw_108:
s_nop 0
v_add_f32_dpp v12, v12, v12 row_ror:4 row_mask:0xf bank_mask:0xf
v_add_f32_dpp v13, v13, v13 row_ror:4 row_mask:0xf bank_mask:0xf
s_nop 0
v_add_f32_dpp v12, v12, v12 row_ror:8 row_mask:0xf bank_mask:0xf
v_add_f32_dpp v13, v13, v13 row_ror:8 row_mask:0xf bank_mask:0xf
s_mov_b64 exec, s[96:97]
ds_write_b64 v5, v[12:13]
s_mov_b64 exec, -1
s_waitcnt lgkmcnt(0)
s_barrier
s_cmp_ge_u32 s3, 2
s_cbranch_scc0 Lwqb_109
ds_read_b64 v[10:11], v125
v_mov_b32 v5, v127
v_mov_b32 v3, v126
ds_read_b128 v[108:111], v3 offset:0
ds_read_b128 v[112:115], v3 offset:512
ds_read_b128 v[12:15], v3 offset:1024
s_waitcnt lgkmcnt(2)
v_mfma_f32_16x16x32_bf16 v[120:123], v[72:75], v[108:111], 0
v_add_f32_dpp v10, v10, v10 row_ror:4 row_mask:0xf bank_mask:0xf
v_add_f32_dpp v11, v11, v11 row_ror:4 row_mask:0xf bank_mask:0xf
s_nop 0
v_add_f32_dpp v10, v10, v10 row_ror:8 row_mask:0xf bank_mask:0xf
v_add_f32_dpp v11, v11, v11 row_ror:8 row_mask:0xf bank_mask:0xf
v_mfma_f32_16x16x32_bf16 v[124:127], v[76:79], v[108:111], 0
s_nop 0
v_permlane32_swap_b32 v10, v11
v_add_f32 v10, v10, v11
v_mov_b32 v11, v10
ds_read_b128 v[108:111], v3 offset:1536
s_waitcnt lgkmcnt(2)
v_mfma_f32_16x16x32_bf16 v[120:123], v[80:83], v[112:115], v[120:123]
v_permlane16_swap_b32 v10, v11
v_add_f32 v10, v10, v11
v_mov_b32 v11, v10
v_mfma_f32_16x16x32_bf16 v[124:127], v[84:87], v[112:115], v[124:127]
s_nop 0
v_permlane32_swap_b32 v10, v11
v_mul_f32 v10, 0x3ae38e39, v10
v_mul_f32 v11, 0x3ae38e39, v11
ds_read_b128 v[112:115], v3 offset:2048
s_waitcnt lgkmcnt(2)
v_mfma_f32_16x16x32_bf16 v[120:123], v[88:91], v[12:15], v[120:123]
v_fma_f32 v11, -v10, v10, v11
v_max_f32 v11, 0, v11
v_add_f32 v11, 0x3727c5ac, v11
v_mfma_f32_16x16x32_bf16 v[124:127], v[92:95], v[12:15], v[124:127]
v_rsq_f32 v11, v11
v_mul_f32 v116, v10, v116
v_mul_f32 v117, v10, v117
s_waitcnt lgkmcnt(1)
v_mfma_f32_16x16x32_bf16 v[120:123], v[96:99], v[108:111], v[120:123]
v_mul_f32 v118, v10, v118
v_mul_f32 v119, v10, v119
v_mfma_f32_16x16x32_bf16 v[124:127], v[100:103], v[108:111], v[124:127]
s_waitcnt lgkmcnt(0)
v_mfma_f32_16x16x32_bf16 v[120:123], v[104:107], v[112:115], v[120:123]
s_nop 7
v_add_f32_dpp v120, v124, v120 row_shl:4 row_mask:0xf bank_mask:0xf
v_add_f32_dpp v121, v125, v121 row_shl:4 row_mask:0xf bank_mask:0xf
v_add_f32_dpp v122, v126, v122 row_shl:4 row_mask:0xf bank_mask:0xf
v_add_f32_dpp v123, v127, v123 row_shl:4 row_mask:0xf bank_mask:0xf
s_cmp_eq_u32 s3, 3
s_cbranch_scc0 Lwqb_109
ds_write_b128 v4, v[120:123]
s_waitcnt lgkmcnt(0)
Lwqb_109:
s_barrier
s_cmp_eq_u32 s3, 2
s_cbranch_scc0 Lw_110
ds_read_b128 v[108:111], v4 offset:2048
v_sub_f32 v120, v120, v116
v_sub_f32 v121, v121, v117
v_sub_f32 v122, v122, v118
v_sub_f32 v123, v123, v119
s_mov_b64 exec, s[96:97]
s_waitcnt lgkmcnt(0)
v_add_f32 v120, v120, v108
v_add_f32 v121, v121, v109
v_add_f32 v122, v122, v110
v_add_f32 v123, v123, v111
v_mul_f32 v120, v11, v120
v_mul_f32 v121, v11, v121
v_mul_f32 v122, v11, v122
v_mul_f32 v123, v11, v123
v_cvt_pk_bf16_f32 v120, v120, v121
v_cvt_pk_bf16_f32 v121, v122, v123
s_cmp_eq_u32 s50, 1
s_cbranch_scc0 Lpl_111
buffer_store_dwordx2 v[120:121], v5, s[40:43], s63 offen
Lpe_112:
s_mov_b64 exec, -1
Lw_110:
v_lshrrev_b32 v10, 4, v0
v_lshlrev_b32 v3, 6, v10
v_and_b32 v11, 3, v0
v_lshl_add_u32 v3, v11, 4, v3
v_add_u32 v3, 147456, v3
s_add_u32 s57, s64, 0
v_lshrrev_b32 v10, 4, v0
v_lshlrev_b32 v10, 7, v10
v_and_b32 v11, 7, v0
v_lshl_add_u32 v10, v11, 4, v10
s_lshl_b32 s56, s3, 12
s_add_u32 s56, s56, 131072
v_add_u32 v11, s56, v1
ds_read_b128 v[108:111], v11 offset:0
ds_read_b128 v[112:115], v11 offset:1024
ds_read_b128 v[116:119], v11 offset:2048
ds_read_b128 v[120:123], v11 offset:3072
v_mov_b32 v72, 0
v_mov_b32 v73, 0
v_mov_b32 v74, 0
v_mov_b32 v75, 0
v_mov_b32 v76, 0
v_mov_b32 v77, 0
v_mov_b32 v78, 0
v_mov_b32 v79, 0
v_mov_b32 v80, 0
v_mov_b32 v81, 0
v_mov_b32 v82, 0
v_mov_b32 v83, 0
v_mov_b32 v84, 0
v_mov_b32 v85, 0
v_mov_b32 v86, 0
v_mov_b32 v87, 0
s_mov_b32 s52, 0
Lpoll_113:
buffer_load_dwordx4 v[100:103], v10, s[40:43], s57 offen sc1
s_waitcnt vmcnt(0)
v_max_u32 v15, v100, v102
v_cmp_eq_u32 vcc, -1, v15
s_cbranch_vccnz Lpretry_114
Lpdone_115:
v_mov_b32_dpp v72, v100 quad_perm:[0,1,2,3] row_mask:0xf bank_mask:0x1
v_mov_b32_dpp v73, v101 quad_perm:[0,1,2,3] row_mask:0xf bank_mask:0x1
v_mov_b32_dpp v74, v102 quad_perm:[0,1,2,3] row_mask:0xf bank_mask:0x1
v_mov_b32_dpp v75, v103 quad_perm:[0,1,2,3] row_mask:0xf bank_mask:0x1
v_mov_b32_dpp v76, v100 row_shl:2 row_mask:0xf bank_mask:0x1
v_mov_b32_dpp v77, v101 row_shl:2 row_mask:0xf bank_mask:0x1
v_mov_b32_dpp v78, v102 row_shl:2 row_mask:0xf bank_mask:0x1
v_mov_b32_dpp v79, v103 row_shl:2 row_mask:0xf bank_mask:0x1
v_mov_b32_dpp v80, v100 row_shl:4 row_mask:0xf bank_mask:0x1
v_mov_b32_dpp v81, v101 row_shl:4 row_mask:0xf bank_mask:0x1
v_mov_b32_dpp v82, v102 row_shl:4 row_mask:0xf bank_mask:0x1
v_mov_b32_dpp v83, v103 row_shl:4 row_mask:0xf bank_mask:0x1
v_mov_b32_dpp v84, v100 row_shl:6 row_mask:0xf bank_mask:0x1
v_mov_b32_dpp v85, v101 row_shl:6 row_mask:0xf bank_mask:0x1
v_mov_b32_dpp v86, v102 row_shl:6 row_mask:0xf bank_mask:0x1
v_mov_b32_dpp v87, v103 row_shl:6 row_mask:0xf bank_mask:0x1
v_mfma_f32_16x16x32_bf16 v[88:91], a[0:3], v[72:75], 0
v_mfma_f32_16x16x32_bf16 v[88:91], a[4:7], v[76:79], v[88:91]
v_mfma_f32_16x16x32_bf16 v[88:91], a[8:11], v[80:83], v[88:91]
v_mfma_f32_16x16x32_bf16 v[88:91], a[12:15], v[84:87], v[88:91]
v_mfma_f32_16x16x32_bf16 v[92:95], a[16:19], v[72:75], 0
v_mfma_f32_16x16x32_bf16 v[92:95], a[20:23], v[76:79], v[92:95]
v_mfma_f32_16x16x32_bf16 v[92:95], a[24:27], v[80:83], v[92:95]
v_mfma_f32_16x16x32_bf16 v[92:95], a[28:31], v[84:87], v[92:95]
v_mfma_f32_16x16x32_bf16 v[96:99], a[32:35], v[72:75], 0
s_nop 2
v_mov_b32 v100, v88
v_mfma_f32_16x16x32_bf16 v[96:99], a[36:39], v[76:79], v[96:99]
v_mov_b32 v101, v89
v_mfma_f32_16x16x32_bf16 v[96:99], a[40:43], v[80:83], v[96:99]
v_mov_b32 v102, v90
v_mfma_f32_16x16x32_bf16 v[96:99], a[44:47], v[84:87], v[96:99]
v_mov_b32 v103, v91
v_mfma_f32_16x16x32_bf16 v[88:91], a[48:51], v[72:75], 0
v_mov_b32_dpp v100, v92 row_shr:2 row_mask:0xf bank_mask:0xf
v_mfma_f32_16x16x32_bf16 v[88:91], a[52:55], v[76:79], v[88:91]
v_mov_b32_dpp v101, v93 row_shr:2 row_mask:0xf bank_mask:0xf
v_mfma_f32_16x16x32_bf16 v[88:91], a[56:59], v[80:83], v[88:91]
v_mov_b32_dpp v102, v94 row_shr:2 row_mask:0xf bank_mask:0xf
v_mfma_f32_16x16x32_bf16 v[88:91], a[60:63], v[84:87], v[88:91]
v_mov_b32_dpp v103, v95 row_shr:2 row_mask:0xf bank_mask:0xf
v_mfma_f32_16x16x32_bf16 v[92:95], a[64:67], v[72:75], 0
v_mov_b32_dpp v100, v96 row_shr:4 row_mask:0xf bank_mask:0xf
v_mfma_f32_16x16x32_bf16 v[92:95], a[68:71], v[76:79], v[92:95]
v_mov_b32_dpp v101, v97 row_shr:4 row_mask:0xf bank_mask:0xf
v_mfma_f32_16x16x32_bf16 v[92:95], a[72:75], v[80:83], v[92:95]
v_mov_b32_dpp v102, v98 row_shr:4 row_mask:0xf bank_mask:0xf
v_mfma_f32_16x16x32_bf16 v[92:95], a[76:79], v[84:87], v[92:95]
v_mov_b32_dpp v103, v99 row_shr:4 row_mask:0xf bank_mask:0xf
v_mfma_f32_16x16x32_bf16 v[96:99], a[80:83], v[72:75], 0
v_mov_b32_dpp v100, v88 row_shr:6 row_mask:0xf bank_mask:0xf
v_mfma_f32_16x16x32_bf16 v[96:99], a[84:87], v[76:79], v[96:99]
v_mov_b32_dpp v101, v89 row_shr:6 row_mask:0xf bank_mask:0xf
v_mfma_f32_16x16x32_bf16 v[96:99], a[88:91], v[80:83], v[96:99]
v_mov_b32_dpp v102, v90 row_shr:6 row_mask:0xf bank_mask:0xf
v_mfma_f32_16x16x32_bf16 v[96:99], a[92:95], v[84:87], v[96:99]
v_mov_b32_dpp v103, v91 row_shr:6 row_mask:0xf bank_mask:0xf
v_mfma_f32_16x16x32_bf16 v[88:91], a[96:99], v[72:75], 0
v_mov_b32_dpp v100, v92 row_shr:8 row_mask:0xf bank_mask:0xf
v_mfma_f32_16x16x32_bf16 v[88:91], a[100:103], v[76:79], v[88:91]
v_mov_b32_dpp v101, v93 row_shr:8 row_mask:0xf bank_mask:0xf
v_mfma_f32_16x16x32_bf16 v[88:91], a[104:107], v[80:83], v[88:91]
v_mov_b32_dpp v102, v94 row_shr:8 row_mask:0xf bank_mask:0xf
v_mfma_f32_16x16x32_bf16 v[88:91], a[108:111], v[84:87], v[88:91]
v_mov_b32_dpp v103, v95 row_shr:8 row_mask:0xf bank_mask:0xf
v_mfma_f32_16x16x32_bf16 v[92:95], a[112:115], v[72:75], 0
v_mov_b32_dpp v100, v96 row_shr:10 row_mask:0xf bank_mask:0xf
v_mfma_f32_16x16x32_bf16 v[92:95], a[116:119], v[76:79], v[92:95]
v_mov_b32_dpp v101, v97 row_shr:10 row_mask:0xf bank_mask:0xf
v_mfma_f32_16x16x32_bf16 v[92:95], a[120:123], v[80:83], v[92:95]
v_mov_b32_dpp v102, v98 row_shr:10 row_mask:0xf bank_mask:0xf
v_mfma_f32_16x16x32_bf16 v[92:95], a[124:127], v[84:87], v[92:95]
v_mov_b32_dpp v103, v99 row_shr:10 row_mask:0xf bank_mask:0xf
v_mfma_f32_16x16x32_bf16 v[96:99], a[128:131], v[72:75], 0
v_mov_b32_dpp v100, v88 row_shr:12 row_mask:0xf bank_mask:0xf
v_mfma_f32_16x16x32_bf16 v[96:99], a[132:135], v[76:79], v[96:99]
v_mov_b32_dpp v101, v89 row_shr:12 row_mask:0xf bank_mask:0xf
v_mfma_f32_16x16x32_bf16 v[96:99], a[136:139], v[80:83], v[96:99]
v_mov_b32_dpp v102, v90 row_shr:12 row_mask:0xf bank_mask:0xf
v_mfma_f32_16x16x32_bf16 v[96:99], a[140:143], v[84:87], v[96:99]
v_mov_b32_dpp v103, v91 row_shr:12 row_mask:0xf bank_mask:0xf
v_mfma_f32_16x16x32_bf16 v[88:91], a[144:147], v[72:75], 0
v_mov_b32_dpp v100, v92 row_shr:14 row_mask:0xf bank_mask:0xf
v_mfma_f32_16x16x32_bf16 v[88:91], a[148:151], v[76:79], v[88:91]
v_mov_b32_dpp v101, v93 row_shr:14 row_mask:0xf bank_mask:0xf
v_mfma_f32_16x16x32_bf16 v[88:91], a[152:155], v[80:83], v[88:91]
v_mov_b32_dpp v102, v94 row_shr:14 row_mask:0xf bank_mask:0xf
v_mfma_f32_16x16x32_bf16 v[88:91], a[156:159], v[84:87], v[88:91]
v_mov_b32_dpp v103, v95 row_shr:14 row_mask:0xf bank_mask:0xf
v_mfma_f32_16x16x32_bf16 v[92:95], a[160:163], v[72:75], 0
v_mov_b32 v104, v96
v_mfma_f32_16x16x32_bf16 v[92:95], a[164:167], v[76:79], v[92:95]
v_mov_b32 v105, v97
v_mfma_f32_16x16x32_bf16 v[92:95], a[168:171], v[80:83], v[92:95]
v_mov_b32 v106, v98
v_mfma_f32_16x16x32_bf16 v[92:95], a[172:175], v[84:87], v[92:95]
v_mov_b32 v107, v99
v_mfma_f32_16x16x32_bf16 v[96:99], a[176:179], v[72:75], 0
v_mov_b32_dpp v104, v88 row_shr:2 row_mask:0xf bank_mask:0xf
v_mfma_f32_16x16x32_bf16 v[96:99], a[180:183], v[76:79], v[96:99]
v_mov_b32_dpp v105, v89 row_shr:2 row_mask:0xf bank_mask:0xf
v_mfma_f32_16x16x32_bf16 v[96:99], a[184:187], v[80:83], v[96:99]
v_mov_b32_dpp v106, v90 row_shr:2 row_mask:0xf bank_mask:0xf
v_mfma_f32_16x16x32_bf16 v[96:99], a[188:191], v[84:87], v[96:99]
v_mov_b32_dpp v107, v91 row_shr:2 row_mask:0xf bank_mask:0xf
v_mfma_f32_16x16x32_bf16 v[88:91], a[192:195], v[72:75], 0
v_mov_b32_dpp v104, v92 row_shr:4 row_mask:0xf bank_mask:0xf
v_mfma_f32_16x16x32_bf16 v[88:91], a[196:199], v[76:79], v[88:91]
v_mov_b32_dpp v105, v93 row_shr:4 row_mask:0xf bank_mask:0xf
v_mfma_f32_16x16x32_bf16 v[88:91], a[200:203], v[80:83], v[88:91]
v_mov_b32_dpp v106, v94 row_shr:4 row_mask:0xf bank_mask:0xf
v_mfma_f32_16x16x32_bf16 v[88:91], a[204:207], v[84:87], v[88:91]
v_mov_b32_dpp v107, v95 row_shr:4 row_mask:0xf bank_mask:0xf
v_mfma_f32_16x16x32_bf16 v[92:95], a[208:211], v[72:75], 0
v_mov_b32_dpp v104, v96 row_shr:6 row_mask:0xf bank_mask:0xf
v_mfma_f32_16x16x32_bf16 v[92:95], a[212:215], v[76:79], v[92:95]
v_mov_b32_dpp v105, v97 row_shr:6 row_mask:0xf bank_mask:0xf
v_mfma_f32_16x16x32_bf16 v[92:95], a[216:219], v[80:83], v[92:95]
v_mov_b32_dpp v106, v98 row_shr:6 row_mask:0xf bank_mask:0xf
v_mfma_f32_16x16x32_bf16 v[92:95], a[220:223], v[84:87], v[92:95]
v_mov_b32_dpp v107, v99 row_shr:6 row_mask:0xf bank_mask:0xf
v_mfma_f32_16x16x32_bf16 v[96:99], a[224:227], v[72:75], 0
v_mov_b32_dpp v104, v88 row_shr:8 row_mask:0xf bank_mask:0xf
v_mfma_f32_16x16x32_bf16 v[96:99], a[228:231], v[76:79], v[96:99]
v_mov_b32_dpp v105, v89 row_shr:8 row_mask:0xf bank_mask:0xf
v_mfma_f32_16x16x32_bf16 v[96:99], a[232:235], v[80:83], v[96:99]
v_mov_b32_dpp v106, v90 row_shr:8 row_mask:0xf bank_mask:0xf
v_mfma_f32_16x16x32_bf16 v[96:99], a[236:239], v[84:87], v[96:99]
v_mov_b32_dpp v107, v91 row_shr:8 row_mask:0xf bank_mask:0xf
s_waitcnt lgkmcnt(0)
v_mfma_f32_16x16x32_bf16 v[88:91], v[108:111], v[72:75], 0
v_mov_b32_dpp v104, v92 row_shr:10 row_mask:0xf bank_mask:0xf
v_mfma_f32_16x16x32_bf16 v[88:91], v[112:115], v[76:79], v[88:91]
v_mov_b32_dpp v105, v93 row_shr:10 row_mask:0xf bank_mask:0xf
v_mfma_f32_16x16x32_bf16 v[88:91], v[116:119], v[80:83], v[88:91]
v_mov_b32_dpp v106, v94 row_shr:10 row_mask:0xf bank_mask:0xf
v_mfma_f32_16x16x32_bf16 v[88:91], v[120:123], v[84:87], v[88:91]
v_mov_b32_dpp v107, v95 row_shr:10 row_mask:0xf bank_mask:0xf
v_mov_b32_dpp v104, v96 row_shr:12 row_mask:0xf bank_mask:0xf
v_mov_b32_dpp v105, v97 row_shr:12 row_mask:0xf bank_mask:0xf
v_mov_b32_dpp v106, v98 row_shr:12 row_mask:0xf bank_mask:0xf
v_mov_b32_dpp v107, v99 row_shr:12 row_mask:0xf bank_mask:0xf
v_add_u32 v10, s70, v1
ds_read_b128 v[112:115], v10 offset:0
ds_read_b128 v[116:119], v10 offset:1024
ds_read_b128 v[124:127], v10 offset:2048
ds_read_b128 v[12:15], v10 offset:3072
v_max3_f32 v11, v100, v101, v102
v_mov_b32_dpp v104, v88 row_shr:14 row_mask:0xf bank_mask:0xf
v_mov_b32_dpp v105, v89 row_shr:14 row_mask:0xf bank_mask:0xf
v_mov_b32_dpp v106, v90 row_shr:14 row_mask:0xf bank_mask:0xf
v_mov_b32_dpp v107, v91 row_shr:14 row_mask:0xf bank_mask:0xf
v_max3_f32 v88, v103, v104, v105
v_max3_f32 v11, v11, v106, v107
v_max_f32 v11, v11, v88
s_nop 1
v_max_f32_dpp v11, v11, v11 row_ror:2 row_mask:0xf bank_mask:0xf
s_nop 1
v_max_f32_dpp v11, v11, v11 row_ror:4 row_mask:0xf bank_mask:0xf
s_nop 1
v_max_f32_dpp v11, v11, v11 row_ror:8 row_mask:0xf bank_mask:0xf
v_mov_b32 v88, v11
s_nop 1
v_permlane16_swap_b32 v11, v88
v_max_f32 v11, v11, v88
v_mov_b32 v88, v11
s_nop 1
v_permlane32_swap_b32 v11, v88
v_max_f32 v11, v11, v88
v_mul_f32 v11, s60, v11
v_fma_f32 v100, v100, s60, -v11
v_fma_f32 v101, v101, s60, -v11
v_fma_f32 v102, v102, s60, -v11
v_fma_f32 v103, v103, s60, -v11
v_fma_f32 v104, v104, s60, -v11
v_fma_f32 v105, v105, s60, -v11
v_fma_f32 v106, v106, s60, -v11
v_fma_f32 v107, v107, s60, -v11
v_exp_f32 v100, v100
v_exp_f32 v101, v101
v_exp_f32 v102, v102
v_exp_f32 v103, v103
v_exp_f32 v104, v104
v_exp_f32 v105, v105
v_exp_f32 v106, v106
v_exp_f32 v107, v107
v_cvt_pk_bf16_f32 v120, v100, v101
v_cvt_pk_bf16_f32 v121, v102, v103
v_cvt_pk_bf16_f32 v122, v104, v105
v_cvt_pk_bf16_f32 v123, v106, v107
v_add_f32 v5, v104, v105
v_add_f32 v88, v106, v107
v_add_f32 v5, v5, v88
v_mov_b32 v104, 0
v_mov_b32 v105, 0
v_mov_b32 v106, 0
v_mov_b32 v107, 0
v_mov_b32 v108, 0
v_mov_b32 v109, 0
v_mov_b32 v110, 0
v_mov_b32 v111, 0
v_mov_b32_dpp v104, v120 quad_perm:[0,1,2,3] row_mask:0xf bank_mask:0x1 bound_ctrl:0
v_mov_b32_dpp v105, v121 quad_perm:[0,1,2,3] row_mask:0xf bank_mask:0x1 bound_ctrl:0
v_mov_b32_dpp v106, v120 row_shl:2 row_mask:0xf bank_mask:0x1 bound_ctrl:0
v_mov_b32_dpp v107, v121 row_shl:2 row_mask:0xf bank_mask:0x1 bound_ctrl:0
v_mov_b32_dpp v108, v122 quad_perm:[0,1,2,3] row_mask:0xf bank_mask:0x1 bound_ctrl:0
v_mov_b32_dpp v109, v123 quad_perm:[0,1,2,3] row_mask:0xf bank_mask:0x1 bound_ctrl:0
v_mov_b32_dpp v110, v122 row_shl:2 row_mask:0xf bank_mask:0x1 bound_ctrl:0
v_mov_b32_dpp v111, v123 row_shl:2 row_mask:0xf bank_mask:0x1 bound_ctrl:0
v_mfma_f32_16x16x32_bf16 v[72:75], v[128:131], v[104:107], 0
v_add_f32 v5, v5, v100
v_mfma_f32_16x16x32_bf16 v[76:79], v[132:135], v[104:107], 0
v_add_f32 v5, v5, v101
v_mfma_f32_16x16x32_bf16 v[80:83], v[136:139], v[104:107], 0
v_add_f32 v5, v5, v102
v_mfma_f32_16x16x32_bf16 v[84:87], v[140:143], v[104:107], 0
v_add_f32 v5, v5, v103
s_waitcnt lgkmcnt(3)
v_mfma_f32_16x16x32_bf16 v[72:75], v[112:115], v[108:111], v[72:75]
ds_read_b128 v[112:115], v10 offset:4096
s_waitcnt lgkmcnt(3)
v_mfma_f32_16x16x32_bf16 v[76:79], v[116:119], v[108:111], v[76:79]
ds_read_b128 v[116:119], v10 offset:5120
s_waitcnt lgkmcnt(3)
v_mfma_f32_16x16x32_bf16 v[80:83], v[124:127], v[108:111], v[80:83]
ds_read_b128 v[124:127], v10 offset:6144
s_waitcnt lgkmcnt(3)
v_mfma_f32_16x16x32_bf16 v[84:87], v[12:15], v[108:111], v[84:87]
ds_read_b128 v[12:15], v10 offset:7168
v_mfma_f32_16x16x32_bf16 v[88:91], v[144:147], v[104:107], 0
v_mfma_f32_16x16x32_bf16 v[92:95], v[148:151], v[104:107], 0
v_mfma_f32_16x16x32_bf16 v[96:99], v[152:155], v[104:107], 0
v_mfma_f32_16x16x32_bf16 v[100:103], v[156:159], v[104:107], 0
v_mov_b32_dpp v104, v120 row_shl:4 row_mask:0xf bank_mask:0x1 bound_ctrl:0
s_waitcnt lgkmcnt(3)
v_mfma_f32_16x16x32_bf16 v[88:91], v[112:115], v[108:111], v[88:91]
ds_read_b128 v[112:115], v10 offset:8192
v_mov_b32_dpp v105, v121 row_shl:4 row_mask:0xf bank_mask:0x1 bound_ctrl:0
s_waitcnt lgkmcnt(3)
v_mfma_f32_16x16x32_bf16 v[92:95], v[116:119], v[108:111], v[92:95]
ds_read_b128 v[116:119], v10 offset:9216
v_mov_b32_dpp v106, v120 row_shl:6 row_mask:0xf bank_mask:0x1 bound_ctrl:0
s_waitcnt lgkmcnt(3)
v_mfma_f32_16x16x32_bf16 v[96:99], v[124:127], v[108:111], v[96:99]
ds_read_b128 v[124:127], v10 offset:10240
v_mov_b32_dpp v107, v121 row_shl:6 row_mask:0xf bank_mask:0x1 bound_ctrl:0
s_waitcnt lgkmcnt(3)
v_mfma_f32_16x16x32_bf16 v[100:103], v[12:15], v[108:111], v[100:103]
ds_read_b128 v[12:15], v10 offset:11264
v_mov_b32_dpp v108, v122 row_shl:4 row_mask:0xf bank_mask:0x1 bound_ctrl:0
v_mfma_f32_16x16x32_bf16 v[72:75], v[160:163], v[104:107], v[72:75]
v_mov_b32_dpp v109, v123 row_shl:4 row_mask:0xf bank_mask:0x1 bound_ctrl:0
v_mfma_f32_16x16x32_bf16 v[76:79], v[164:167], v[104:107], v[76:79]
v_mov_b32_dpp v110, v122 row_shl:6 row_mask:0xf bank_mask:0x1 bound_ctrl:0
v_mfma_f32_16x16x32_bf16 v[80:83], v[168:171], v[104:107], v[80:83]
v_mov_b32_dpp v111, v123 row_shl:6 row_mask:0xf bank_mask:0x1 bound_ctrl:0
v_mfma_f32_16x16x32_bf16 v[84:87], v[172:175], v[104:107], v[84:87]
s_waitcnt lgkmcnt(3)
v_mfma_f32_16x16x32_bf16 v[72:75], v[112:115], v[108:111], v[72:75]
ds_read_b128 v[112:115], v10 offset:12288
s_waitcnt lgkmcnt(3)
v_mfma_f32_16x16x32_bf16 v[76:79], v[116:119], v[108:111], v[76:79]
ds_read_b128 v[116:119], v10 offset:13312
s_waitcnt lgkmcnt(3)
v_mfma_f32_16x16x32_bf16 v[80:83], v[124:127], v[108:111], v[80:83]
ds_read_b128 v[124:127], v10 offset:14336
s_waitcnt lgkmcnt(3)
v_mfma_f32_16x16x32_bf16 v[84:87], v[12:15], v[108:111], v[84:87]
ds_read_b128 v[12:15], v10 offset:15360
v_mfma_f32_16x16x32_bf16 v[88:91], v[176:179], v[104:107], v[88:91]
v_mfma_f32_16x16x32_bf16 v[92:95], v[180:183], v[104:107], v[92:95]
v_mfma_f32_16x16x32_bf16 v[96:99], v[184:187], v[104:107], v[96:99]
v_mfma_f32_16x16x32_bf16 v[100:103], v[188:191], v[104:107], v[100:103]
v_mov_b32_dpp v104, v120 row_shl:8 row_mask:0xf bank_mask:0x1 bound_ctrl:0
s_waitcnt lgkmcnt(3)
v_mfma_f32_16x16x32_bf16 v[88:91], v[112:115], v[108:111], v[88:91]
ds_read_b64_tr_b16 v[112:113], v2 offset:16384
ds_read_b64_tr_b16 v[114:115], v2 offset:20480
v_mov_b32_dpp v105, v121 row_shl:8 row_mask:0xf bank_mask:0x1 bound_ctrl:0
s_waitcnt lgkmcnt(4)
v_mfma_f32_16x16x32_bf16 v[92:95], v[116:119], v[108:111], v[92:95]
v_xor_b32 v10, 32, v2
ds_read_b64_tr_b16 v[116:117], v10 offset:16384
ds_read_b64_tr_b16 v[118:119], v10 offset:20480
v_mov_b32_dpp v106, v120 row_shl:10 row_mask:0xf bank_mask:0x1 bound_ctrl:0
s_waitcnt lgkmcnt(5)
v_mfma_f32_16x16x32_bf16 v[96:99], v[124:127], v[108:111], v[96:99]
v_xor_b32 v10, 64, v2
ds_read_b64_tr_b16 v[124:125], v10 offset:16384
ds_read_b64_tr_b16 v[126:127], v10 offset:20480
v_mov_b32_dpp v107, v121 row_shl:10 row_mask:0xf bank_mask:0x1 bound_ctrl:0
s_waitcnt lgkmcnt(6)
v_mfma_f32_16x16x32_bf16 v[100:103], v[12:15], v[108:111], v[100:103]
v_xor_b32 v10, 96, v2
ds_read_b64_tr_b16 v[12:13], v10 offset:16384
ds_read_b64_tr_b16 v[14:15], v10 offset:20480
v_mov_b32_dpp v108, v122 row_shl:8 row_mask:0xf bank_mask:0x1 bound_ctrl:0
v_mfma_f32_16x16x32_bf16 v[72:75], v[192:195], v[104:107], v[72:75]
v_mov_b32_dpp v109, v123 row_shl:8 row_mask:0xf bank_mask:0x1 bound_ctrl:0
v_mfma_f32_16x16x32_bf16 v[76:79], v[196:199], v[104:107], v[76:79]
v_mov_b32_dpp v110, v122 row_shl:10 row_mask:0xf bank_mask:0x1 bound_ctrl:0
v_mfma_f32_16x16x32_bf16 v[80:83], v[200:203], v[104:107], v[80:83]
v_mov_b32_dpp v111, v123 row_shl:10 row_mask:0xf bank_mask:0x1 bound_ctrl:0
v_mfma_f32_16x16x32_bf16 v[84:87], v[204:207], v[104:107], v[84:87]
s_waitcnt lgkmcnt(6)
v_mfma_f32_16x16x32_bf16 v[72:75], v[112:115], v[108:111], v[72:75]
v_xor_b32 v10, 128, v2
ds_read_b64_tr_b16 v[112:113], v10 offset:16384
ds_read_b64_tr_b16 v[114:115], v10 offset:20480
s_waitcnt lgkmcnt(6)
v_mfma_f32_16x16x32_bf16 v[76:79], v[116:119], v[108:111], v[76:79]
v_xor_b32 v10, 160, v2
ds_read_b64_tr_b16 v[116:117], v10 offset:16384
ds_read_b64_tr_b16 v[118:119], v10 offset:20480
s_waitcnt lgkmcnt(6)
v_mfma_f32_16x16x32_bf16 v[80:83], v[124:127], v[108:111], v[80:83]
v_xor_b32 v10, 192, v2
ds_read_b64_tr_b16 v[124:125], v10 offset:16384
ds_read_b64_tr_b16 v[126:127], v10 offset:20480
s_waitcnt lgkmcnt(6)
v_mfma_f32_16x16x32_bf16 v[84:87], v[12:15], v[108:111], v[84:87]
v_xor_b32 v10, 224, v2
ds_read_b64_tr_b16 v[12:13], v10 offset:16384
ds_read_b64_tr_b16 v[14:15], v10 offset:20480
v_mfma_f32_16x16x32_bf16 v[88:91], v[208:211], v[104:107], v[88:91]
v_mfma_f32_16x16x32_bf16 v[92:95], v[212:215], v[104:107], v[92:95]
v_mfma_f32_16x16x32_bf16 v[96:99], v[216:219], v[104:107], v[96:99]
v_mfma_f32_16x16x32_bf16 v[100:103], v[220:223], v[104:107], v[100:103]
v_mov_b32_dpp v104, v120 row_shl:12 row_mask:0xf bank_mask:0x1 bound_ctrl:0
s_waitcnt lgkmcnt(6)
v_mfma_f32_16x16x32_bf16 v[88:91], v[112:115], v[108:111], v[88:91]
ds_read_b64_tr_b16 v[112:113], v2 offset:24576
ds_read_b64_tr_b16 v[114:115], v2 offset:28672
v_mov_b32_dpp v105, v121 row_shl:12 row_mask:0xf bank_mask:0x1 bound_ctrl:0
s_waitcnt lgkmcnt(6)
v_mfma_f32_16x16x32_bf16 v[92:95], v[116:119], v[108:111], v[92:95]
v_xor_b32 v10, 32, v2
ds_read_b64_tr_b16 v[116:117], v10 offset:24576
ds_read_b64_tr_b16 v[118:119], v10 offset:28672
v_mov_b32_dpp v106, v120 row_shl:14 row_mask:0xf bank_mask:0x1 bound_ctrl:0
s_waitcnt lgkmcnt(6)
v_mfma_f32_16x16x32_bf16 v[96:99], v[124:127], v[108:111], v[96:99]
v_xor_b32 v10, 64, v2
ds_read_b64_tr_b16 v[124:125], v10 offset:24576
ds_read_b64_tr_b16 v[126:127], v10 offset:28672
v_mov_b32_dpp v107, v121 row_shl:14 row_mask:0xf bank_mask:0x1 bound_ctrl:0
s_waitcnt lgkmcnt(6)
v_mfma_f32_16x16x32_bf16 v[100:103], v[12:15], v[108:111], v[100:103]
v_xor_b32 v10, 96, v2
ds_read_b64_tr_b16 v[12:13], v10 offset:24576
ds_read_b64_tr_b16 v[14:15], v10 offset:28672
v_mov_b32_dpp v108, v122 row_shl:12 row_mask:0xf bank_mask:0x1 bound_ctrl:0
v_mov_b32_dpp v109, v123 row_shl:12 row_mask:0xf bank_mask:0x1 bound_ctrl:0
v_mfma_f32_16x16x32_bf16 v[72:75], v[224:227], v[104:107], v[72:75]
v_mov_b32_dpp v110, v122 row_shl:14 row_mask:0xf bank_mask:0x1 bound_ctrl:0
v_mov_b32_dpp v111, v123 row_shl:14 row_mask:0xf bank_mask:0x1 bound_ctrl:0
v_mfma_f32_16x16x32_bf16 v[76:79], v[228:231], v[104:107], v[76:79]
s_waitcnt lgkmcnt(6)
v_mfma_f32_16x16x32_bf16 v[72:75], v[112:115], v[108:111], v[72:75]
v_xor_b32 v10, 128, v2
ds_read_b64_tr_b16 v[112:113], v10 offset:24576
ds_read_b64_tr_b16 v[114:115], v10 offset:28672
s_waitcnt lgkmcnt(6)
v_mfma_f32_16x16x32_bf16 v[76:79], v[116:119], v[108:111], v[76:79]
v_xor_b32 v10, 160, v2
ds_read_b64_tr_b16 v[116:117], v10 offset:24576
ds_read_b64_tr_b16 v[118:119], v10 offset:28672
v_mfma_f32_16x16x32_bf16 v[80:83], v[232:235], v[104:107], v[80:83]
v_mfma_f32_16x16x32_bf16 v[84:87], v[236:239], v[104:107], v[84:87]
s_waitcnt lgkmcnt(6)
v_mfma_f32_16x16x32_bf16 v[80:83], v[124:127], v[108:111], v[80:83]
v_xor_b32 v10, 192, v2
ds_read_b64_tr_b16 v[124:125], v10 offset:24576
ds_read_b64_tr_b16 v[126:127], v10 offset:28672
s_waitcnt lgkmcnt(6)
v_mfma_f32_16x16x32_bf16 v[84:87], v[12:15], v[108:111], v[84:87]
v_xor_b32 v10, 224, v2
ds_read_b64_tr_b16 v[12:13], v10 offset:24576
ds_read_b64_tr_b16 v[14:15], v10 offset:28672
v_mov_b32 v120, v72
v_mov_b32 v121, v73
v_mfma_f32_16x16x32_bf16 v[88:91], v[240:243], v[104:107], v[88:91]
v_mov_b32 v122, v74
v_mov_b32 v123, v75
v_mfma_f32_16x16x32_bf16 v[92:95], v[244:247], v[104:107], v[92:95]
v_mov_b32_dpp v120, v76 row_shr:2 row_mask:0xf bank_mask:0xf
v_mov_b32_dpp v121, v77 row_shr:2 row_mask:0xf bank_mask:0xf
s_waitcnt lgkmcnt(6)
v_mfma_f32_16x16x32_bf16 v[88:91], v[112:115], v[108:111], v[88:91]
v_mov_b32_dpp v122, v78 row_shr:2 row_mask:0xf bank_mask:0xf
v_mov_b32_dpp v123, v79 row_shr:2 row_mask:0xf bank_mask:0xf
s_waitcnt lgkmcnt(4)
v_mfma_f32_16x16x32_bf16 v[92:95], v[116:119], v[108:111], v[92:95]
v_mov_b32_dpp v120, v80 row_shr:4 row_mask:0xf bank_mask:0xf
v_mov_b32_dpp v121, v81 row_shr:4 row_mask:0xf bank_mask:0xf
v_mfma_f32_16x16x32_bf16 v[96:99], v[248:251], v[104:107], v[96:99]
v_mov_b32_dpp v122, v82 row_shr:4 row_mask:0xf bank_mask:0xf
v_mov_b32_dpp v123, v83 row_shr:4 row_mask:0xf bank_mask:0xf
v_mfma_f32_16x16x32_bf16 v[100:103], v[252:255], v[104:107], v[100:103]
v_mov_b32_dpp v120, v84 row_shr:6 row_mask:0xf bank_mask:0xf
v_mov_b32_dpp v121, v85 row_shr:6 row_mask:0xf bank_mask:0xf
s_waitcnt lgkmcnt(2)
v_mfma_f32_16x16x32_bf16 v[96:99], v[124:127], v[108:111], v[96:99]
v_mov_b32_dpp v122, v86 row_shr:6 row_mask:0xf bank_mask:0xf
v_mov_b32_dpp v123, v87 row_shr:6 row_mask:0xf bank_mask:0xf
s_waitcnt lgkmcnt(0)
v_mfma_f32_16x16x32_bf16 v[100:103], v[12:15], v[108:111], v[100:103]
v_mov_b32_dpp v120, v88 row_shr:8 row_mask:0xf bank_mask:0xf
v_mov_b32_dpp v121, v89 row_shr:8 row_mask:0xf bank_mask:0xf
v_add_f32_dpp v5, v5, v5 row_ror:2 row_mask:0xf bank_mask:0xf
s_nop 1
v_add_f32_dpp v5, v5, v5 row_ror:4 row_mask:0xf bank_mask:0xf
s_nop 1
v_add_f32_dpp v5, v5, v5 row_ror:8 row_mask:0xf bank_mask:0xf
v_mov_b32 v104, v5
v_mov_b32_dpp v122, v90 row_shr:8 row_mask:0xf bank_mask:0xf
v_mov_b32_dpp v123, v91 row_shr:8 row_mask:0xf bank_mask:0xf
v_permlane16_swap_b32 v5, v104
v_mov_b32_dpp v120, v92 row_shr:10 row_mask:0xf bank_mask:0xf
v_mov_b32_dpp v121, v93 row_shr:10 row_mask:0xf bank_mask:0xf
v_add_f32 v5, v5, v104
v_mov_b32_dpp v122, v94 row_shr:10 row_mask:0xf bank_mask:0xf
v_mov_b32_dpp v123, v95 row_shr:10 row_mask:0xf bank_mask:0xf
v_mov_b32 v104, v5
v_mov_b32_dpp v120, v96 row_shr:12 row_mask:0xf bank_mask:0xf
v_mov_b32_dpp v121, v97 row_shr:12 row_mask:0xf bank_mask:0xf
v_permlane32_swap_b32 v5, v104
v_mov_b32_dpp v122, v98 row_shr:12 row_mask:0xf bank_mask:0xf
v_mov_b32_dpp v123, v99 row_shr:12 row_mask:0xf bank_mask:0xf
v_add_f32 v5, v5, v104
v_mov_b32_dpp v120, v100 row_shr:14 row_mask:0xf bank_mask:0xf
v_mov_b32_dpp v121, v101 row_shr:14 row_mask:0xf bank_mask:0xf
v_mov_b32_dpp v122, v102 row_shr:14 row_mask:0xf bank_mask:0xf
v_mov_b32_dpp v123, v103 row_shr:14 row_mask:0xf bank_mask:0xf
s_lshl_b32 s55, s3, 10
s_add_u32 s55, s55, 147456
v_add_u32 v10, s55, v1
ds_write_b128 v10, v[120:123]
v_and_b32 v12, 1, v0
v_lshlrev_b32 v12, 3, v12
v_add_u32 v12, 151552, v12
s_lshl_b32 s55, s3, 4
v_add_u32 v13, s55, v12
s_mov_b64 exec, 3
ds_write2_b32 v13, v11, v5 offset0:0 offset1:1
s_mov_b64 exec, -1
s_waitcnt lgkmcnt(0)
s_barrier
s_cmp_eq_u32 s3, 0
s_cbranch_scc0 Lw_116
ds_read_b64 v[76:77], v12 offset:0
ds_read_b64 v[78:79], v12 offset:16
ds_read_b64 v[80:81], v12 offset:32
ds_read_b64 v[82:83], v12 offset:48
ds_read_b128 v[84:87], v10 offset:1024
ds_read_b128 v[88:91], v10 offset:2048
ds_read_b128 v[92:95], v10 offset:3072
v_and_b32 v12, 1, v0
v_lshlrev_b32 v12, 12, v12
v_bfe_u32 v13, v0, 2, 2
v_lshl_add_u32 v12, v13, 10, v12
v_bfe_u32 v13, v0, 1, 1
v_lshl_add_u32 v12, v13, 9, v12
v_lshrrev_b32 v13, 5, v0
v_lshl_add_u32 v12, v13, 8, v12
v_bfe_u32 v13, v0, 4, 1
v_lshl_add_u32 v12, v13, 3, v12
s_add_u32 s55, s66, 16384
s_add_u32 s58, s67, 512
v_mov_b32 v14, 0
s_waitcnt lgkmcnt(3)
v_max3_f32 v96, v76, v78, v80
v_max_f32 v96, v96, v82
v_sub_f32 v76, v76, v96
v_sub_f32 v78, v78, v96
v_sub_f32 v80, v80, v96
v_sub_f32 v82, v82, v96
v_exp_f32 v76, v76
v_exp_f32 v78, v78
v_exp_f32 v80, v80
v_exp_f32 v82, v82
v_mul_f32 v97, v76, v77
v_fmac_f32 v97, v78, v79
v_fmac_f32 v97, v80, v81
v_fmac_f32 v97, v82, v83
v_rcp_f32 v13, v97
v_mul_f32 v120, v76, v120
v_mul_f32 v121, v76, v121
v_mul_f32 v122, v76, v122
v_mul_f32 v123, v76, v123
s_waitcnt lgkmcnt(0)
v_fmac_f32 v120, v78, v84
v_fmac_f32 v121, v78, v85
v_fmac_f32 v122, v78, v86
v_fmac_f32 v123, v78, v87
v_fmac_f32 v120, v80, v88
v_fmac_f32 v121, v80, v89
v_fmac_f32 v122, v80, v90
v_fmac_f32 v123, v80, v91
v_fmac_f32 v120, v82, v92
v_fmac_f32 v121, v82, v93
v_fmac_f32 v122, v82, v94
v_fmac_f32 v123, v82, v95
v_mul_f32 v120, v13, v120
v_mul_f32 v121, v13, v121
v_mul_f32 v122, v13, v122
v_mul_f32 v123, v13, v123
v_mov_b32_dpp v98, v96 quad_perm:[1,1,1,1] row_mask:0xf bank_mask:0xf
v_mov_b32_dpp v99, v97 quad_perm:[1,1,1,1] row_mask:0xf bank_mask:0xf
v_cvt_pk_bf16_f32 v120, v120, v121
v_cvt_pk_bf16_f32 v121, v122, v123
s_cmp_eq_u32 s50, 1
s_cbranch_scc0 Lpl_117
buffer_store_dwordx2 v[120:121], v12, s[40:43], s55 offen
s_mov_b64 exec, 1
buffer_store_dwordx4 v[96:99], v14, s[40:43], s58 offen
Lpe_118:
s_mov_b64 exec, -1
Lw_116:
s_barrier
s_cmp_lt_u32 s49, 18
s_cbranch_scc1 Lffn_119
s_cmp_lt_u32 s49, 30
s_cbranch_scc0 Lidle_120
s_sub_u32 s59, s49, 18
s_mul_i32 s61, s59, 3
s_add_u32 s61, s61, s3
s_sub_u32 s61, s61, 1
s_cmp_lg_u32 s3, 0
s_cbranch_scc0 Lw_122
v_mov_b32 v13, 0
v_lshrrev_b32 v10, 4, v0
v_bfe_u32 v11, v0, 2, 2
v_and_b32 v14, 3, v0
v_lshlrev_b32 v12, 4, v14
v_and_b32 v15, 1, v11
v_lshl_add_u32 v12, v15, 3, v12
v_lshrrev_b32 v15, 1, v11
v_lshl_add_u32 v12, v15, 6, v12
v_lshl_add_u32 v5, v10, 1, v12
s_lshl_b32 s55, s61, 7
s_add_u32 s55, s55, s53
s_add_u32 s55, s55, 42496
buffer_load_short_d16_hi v13, v5, s[40:43], s55 offen sc1
v_lshrrev_b32 v10, 5, v0
v_lshl_add_u32 v12, v10, 2, v12
s_lshl_b32 s63, s61, 7
s_add_u32 s63, s63, s53
s_add_u32 s63, s63, 47104
Lw_122:
s_lshl_b32 s55, s62, 13
s_add_u32 s55, s55, s53
s_add_u32 s55, s55, 20480
s_lshl_b32 s56, s3, 11
s_add_u32 s55, s55, s56
s_add_u32 s57, s56, 147456
v_add_u32 v10, s57, v1
v_and_b32 v11, 0xff, v1
s_add_u32 s56, s56, 155648
v_add_u32 v126, s56, v11
v_add_u32 v127, 147456, v1
v_lshrrev_b32 v5, 4, v0
v_lshlrev_b32 v5, 6, v5
v_and_b32 v14, 3, v0
v_lshl_add_u32 v5, v14, 4, v5
s_add_u32 s58, s68, 294912
s_cmp_eq_u32 s3, 0
s_cbranch_scc0 Lwoo_123
s_lshl_b32 s57, s62, 8
s_add_u32 s57, s57, s53
s_add_u32 s57, s57, 37376
v_lshrrev_b32 v12, 4, v0
v_lshl_add_u32 v12, v12, 11, v11
v_add_u32 v12, 155648, v12
s_mov_b32 s52, 0
Lpoll_125:
buffer_load_dwordx4 v[104:107], v1, s[40:43], s55 offen offset:0 sc1
buffer_load_dwordx4 v[108:111], v1, s[40:43], s55 offen offset:1024 sc1
buffer_load_dwordx4 v[112:115], v11, s[40:43], s57 offen sc1
s_waitcnt vmcnt(0)
v_max3_u32 v15, v104, v106, v108
v_max3_u32 v15, v15, v110, v112
v_cmp_eq_u32 vcc, -1, v15
s_cbranch_vccnz Lpretry_126
Lpdone_127:
ds_write_b128 v12, v[112:115]
s_branch Lwod_124
Lwoo_123:
s_mov_b32 s52, 0
Lpoll_128:
buffer_load_dwordx4 v[104:107], v1, s[40:43], s55 offen offset:0 sc1
buffer_load_dwordx4 v[108:111], v1, s[40:43], s55 offen offset:1024 sc1
s_waitcnt vmcnt(0)
v_max3_u32 v15, v104, v106, v108
v_max_u32 v15, v15, v110
v_cmp_eq_u32 vcc, -1, v15
s_cbranch_vccnz Lpretry_129
Lpdone_130:
Lwod_124:
ds_write_b128 v10, v[104:107]
ds_write_b128 v10, v[108:111] offset:1024
s_waitcnt lgkmcnt(0)
s_barrier
ds_read_b128 v[120:123], v126
ds_read_b128 v[72:75], v127 offset:0
ds_read_b128 v[76:79], v127 offset:1024
ds_read_b128 v[80:83], v127 offset:2048
ds_read_b128 v[84:87], v127 offset:3072
ds_read_b128 v[88:91], v127 offset:4096
ds_read_b128 v[92:95], v127 offset:5120
ds_read_b128 v[96:99], v127 offset:6144
ds_read_b128 v[100:103], v127 offset:7168
s_waitcnt lgkmcnt(8)
v_max_f32_dpp v124, v120, v120 row_ror:4 row_mask:0xf bank_mask:0xf
v_max_f32_dpp v125, v122, v122 row_ror:4 row_mask:0xf bank_mask:0xf
s_nop 0
v_max_f32_dpp v124, v124, v124 row_ror:8 row_mask:0xf bank_mask:0xf
v_max_f32_dpp v125, v125, v125 row_ror:8 row_mask:0xf bank_mask:0xf
s_waitcnt lgkmcnt(7)
v_mfma_f32_16x16x32_bf16 v[104:107], v[16:19], v[72:75], 0
v_sub_f32 v120, v120, v124
v_sub_f32 v122, v122, v125
s_waitcnt lgkmcnt(6)
v_mfma_f32_16x16x32_bf16 v[104:107], v[24:27], v[76:79], v[104:107]
v_exp_f32 v120, v120
v_exp_f32 v122, v122
s_waitcnt lgkmcnt(5)
v_mfma_f32_16x16x32_bf16 v[104:107], v[32:35], v[80:83], v[104:107]
v_mul_f32 v120, v120, v121
v_mul_f32 v122, v122, v123
s_waitcnt lgkmcnt(4)
v_mfma_f32_16x16x32_bf16 v[104:107], v[40:43], v[84:87], v[104:107]
v_add_f32_dpp v124, v120, v120 row_ror:4 row_mask:0xf bank_mask:0xf
v_add_f32_dpp v125, v122, v122 row_ror:4 row_mask:0xf bank_mask:0xf
s_waitcnt lgkmcnt(3)
v_mfma_f32_16x16x32_bf16 v[108:111], v[48:51], v[88:91], 0
v_add_f32_dpp v124, v124, v124 row_ror:8 row_mask:0xf bank_mask:0xf
v_add_f32_dpp v125, v125, v125 row_ror:8 row_mask:0xf bank_mask:0xf
s_waitcnt lgkmcnt(2)
v_mfma_f32_16x16x32_bf16 v[108:111], v[56:59], v[92:95], v[108:111]
v_rcp_f32 v124, v124
v_rcp_f32 v125, v125
s_waitcnt lgkmcnt(1)
v_mfma_f32_16x16x32_bf16 v[108:111], v[64:67], v[96:99], v[108:111]
v_mul_f32 v120, v120, v124
v_mul_f32 v122, v122, v125
s_waitcnt lgkmcnt(0)
v_mfma_f32_16x16x32_bf16 v[108:111], a[240:243], v[100:103], v[108:111]
s_cmp_ge_u32 s3, 2
s_cbranch_scc1 Lwo1t_131
v_mfma_f32_16x16x32_bf16 v[112:115], v[20:23], v[72:75], 0
v_mfma_f32_16x16x32_bf16 v[112:115], v[28:31], v[76:79], v[112:115]
v_mfma_f32_16x16x32_bf16 v[112:115], v[36:39], v[80:83], v[112:115]
v_mfma_f32_16x16x32_bf16 v[112:115], v[44:47], v[84:87], v[112:115]
v_mul_f32 v104, v120, v104
v_mul_f32 v105, v120, v105
v_mul_f32 v106, v120, v106
v_mfma_f32_16x16x32_bf16 v[116:119], v[52:55], v[88:91], 0
v_mul_f32 v107, v120, v107
v_fmac_f32 v104, v122, v108
v_fmac_f32 v105, v122, v109
v_mfma_f32_16x16x32_bf16 v[116:119], v[60:63], v[92:95], v[116:119]
v_fmac_f32 v106, v122, v110
v_fmac_f32 v107, v122, v111
v_add_f32_dpp v104, v104, v104 row_ror:4 row_mask:0xf bank_mask:0xf
v_mfma_f32_16x16x32_bf16 v[116:119], v[68:71], v[96:99], v[116:119]
v_add_f32_dpp v105, v105, v105 row_ror:4 row_mask:0xf bank_mask:0xf
v_add_f32_dpp v106, v106, v106 row_ror:4 row_mask:0xf bank_mask:0xf
v_add_f32_dpp v107, v107, v107 row_ror:4 row_mask:0xf bank_mask:0xf
v_mfma_f32_16x16x32_bf16 v[116:119], a[244:247], v[100:103], v[116:119]
v_add_f32_dpp v104, v104, v104 row_ror:8 row_mask:0xf bank_mask:0xf
v_add_f32_dpp v105, v105, v105 row_ror:8 row_mask:0xf bank_mask:0xf
v_add_f32_dpp v106, v106, v106 row_ror:8 row_mask:0xf bank_mask:0xf
v_add_f32_dpp v107, v107, v107 row_ror:8 row_mask:0xf bank_mask:0xf
s_mov_b64 exec, s[96:97]
buffer_store_dwordx4 v[104:107], v5, s[40:43], s58 offen offset:0 sc1
s_mov_b64 exec, -1
s_add_u32 s58, s58, 4096
v_mul_f32 v112, v120, v112
v_mul_f32 v113, v120, v113
v_mul_f32 v114, v120, v114
v_mul_f32 v115, v120, v115
v_fmac_f32 v112, v122, v116
v_fmac_f32 v113, v122, v117
v_fmac_f32 v114, v122, v118
v_fmac_f32 v115, v122, v119
v_add_f32_dpp v112, v112, v112 row_ror:4 row_mask:0xf bank_mask:0xf
v_add_f32_dpp v113, v113, v113 row_ror:4 row_mask:0xf bank_mask:0xf
v_add_f32_dpp v114, v114, v114 row_ror:4 row_mask:0xf bank_mask:0xf
v_add_f32_dpp v115, v115, v115 row_ror:4 row_mask:0xf bank_mask:0xf
v_add_f32_dpp v112, v112, v112 row_ror:8 row_mask:0xf bank_mask:0xf
v_add_f32_dpp v113, v113, v113 row_ror:8 row_mask:0xf bank_mask:0xf
v_add_f32_dpp v114, v114, v114 row_ror:8 row_mask:0xf bank_mask:0xf
v_add_f32_dpp v115, v115, v115 row_ror:8 row_mask:0xf bank_mask:0xf
s_mov_b64 exec, s[96:97]
buffer_store_dwordx4 v[112:115], v5, s[40:43], s58 offen offset:0 sc1
s_mov_b64 exec, -1
s_branch Lwof_132
Lwo1t_131:
v_mul_f32 v104, v120, v104
v_mul_f32 v105, v120, v105
v_mul_f32 v106, v120, v106
v_mul_f32 v107, v120, v107
s_nop 1
v_fmac_f32 v104, v122, v108
v_fmac_f32 v105, v122, v109
v_fmac_f32 v106, v122, v110
v_fmac_f32 v107, v122, v111
v_add_f32_dpp v104, v104, v104 row_ror:4 row_mask:0xf bank_mask:0xf
v_add_f32_dpp v105, v105, v105 row_ror:4 row_mask:0xf bank_mask:0xf
v_add_f32_dpp v106, v106, v106 row_ror:4 row_mask:0xf bank_mask:0xf
v_add_f32_dpp v107, v107, v107 row_ror:4 row_mask:0xf bank_mask:0xf
v_add_f32_dpp v104, v104, v104 row_ror:8 row_mask:0xf bank_mask:0xf
v_add_f32_dpp v105, v105, v105 row_ror:8 row_mask:0xf bank_mask:0xf
v_add_f32_dpp v106, v106, v106 row_ror:8 row_mask:0xf bank_mask:0xf
v_add_f32_dpp v107, v107, v107 row_ror:8 row_mask:0xf bank_mask:0xf
s_mov_b64 exec, s[96:97]
buffer_store_dwordx4 v[104:107], v5, s[40:43], s58 offen offset:0 sc1
s_mov_b64 exec, -1
Lwof_132:
s_cmp_lg_u32 s3, 0
s_cbranch_scc0 Lw_133
s_lshl_b32 s55, s61, 12
s_add_u32 s55, s55, 884736
s_waitcnt vmcnt(0)
s_mov_b32 s52, 0
Lpoll_134:
buffer_load_dwordx4 v[72:75], v1, s[40:43], s55 offen offset:0 sc1
buffer_load_dwordx4 v[76:79], v1, s[40:43], s55 offen offset:1024 sc1
buffer_load_dwordx4 v[80:83], v1, s[40:43], s55 offen offset:2048 sc1
buffer_load_dwordx4 v[84:87], v1, s[40:43], s55 offen offset:3072 sc1
s_waitcnt vmcnt(0)
v_max3_u32 v15, v72, v76, v80
v_max_u32 v15, v15, v84
v_cmp_eq_u32 vcc, -1, v15
s_cbranch_vccnz Lpretry_135
Lpdone_136:
v_add_f32 v72, v72, v76
v_add_f32 v80, v80, v84
v_add_f32 v73, v73, v77
v_add_f32 v81, v81, v85
v_add_f32 v74, v74, v78
v_add_f32 v82, v82, v86
v_add_f32 v75, v75, v79
v_add_f32 v83, v83, v87
v_add_f32 v72, v72, v80
v_add_f32 v74, v74, v82
v_add_f32 v73, v73, v81
v_add_f32 v75, v75, v83
v_permlane32_swap_b32 v72, v74
s_nop 0
v_permlane32_swap_b32 v73, v75
v_add_f32 v72, v72, v74
v_add_f32 v73, v73, v75
s_nop 1
v_permlane16_swap_b32 v72, v73
v_add_f32 v72, v72, v73
v_cvt_pk_bf16_f32 v72, v72, v72
v_and_b32 v72, 0xffff0000, v72
v_add_f32 v72, v72, v13
v_mov_b32 v73, v72
s_nop 1
v_permlane16_swap_b32 v72, v73
v_cvt_pk_bf16_f32 v72, v72, v73
s_mov_b32 exec_lo, 0xffff
s_mov_b32 exec_hi, 0xffff
s_cmp_eq_u32 s50, 1
s_cbranch_scc0 Lpl_137
buffer_store_dword v72, v12, s[40:43], s63 offen
Lpe_138:
s_mov_b64 exec, -1
Lw_133:
Lidle_120:
s_endpgm
Lffn_119:
v_lshrrev_b32 v14, 4, v0
v_bfe_u32 v15, v0, 2, 2
v_lshl_add_u32 v14, v14, 3, v15
s_lshl_b32 s55, s3, 10
s_add_u32 s55, s55, 147456
v_add_u32 v110, s55, v1
s_lshl_b32 s55, s3, 11
s_add_u32 s55, s55, 147456
v_add_u32 v113, s55, v1
v_lshlrev_b32 v112, 7, v14
v_and_b32 v15, 3, v0
v_lshl_add_u32 v112, v15, 3, v112
s_lshl_b32 s55, s3, 5
s_add_u32 s55, s55, 147456
v_add_u32 v112, s55, v112
s_mul_i32 s57, s62, 9
s_sub_u32 s57, s49, s57
s_lshl_b32 s57, s57, 7
s_mul_i32 s55, s48, 663552
s_add_u32 s57, s57, s55
s_mul_i32 s55, s62, 331776
s_add_u32 s57, s57, s55
v_lshrrev_b32 v109, 3, v0
s_mov_b32 s55, 1152
v_mul_lo_u32 v109, v109, s55
v_and_b32 v15, 7, v0
v_lshl_add_u32 v109, v15, 4, v109
s_mul_i32 s55, s3, 9216
s_add_u32 s58, s57, s55
s_add_u32 s57, s58, s55
s_add_u32 s58, s58, 294912
buffer_load_dwordx4 v[72:75], v109, s[28:31], s57 offen nt
s_add_u32 s57, s57, 9216
buffer_load_dwordx4 v[76:79], v109, s[28:31], s57 offen nt
s_add_u32 s57, s57, 64512
buffer_load_dwordx4 v[80:83], v109, s[28:31], s57 offen nt
s_add_u32 s57, s57, 9216
buffer_load_dwordx4 v[84:87], v109, s[28:31], s57 offen nt
s_add_u32 s57, s57, 64512
buffer_load_dwordx4 v[88:91], v109, s[28:31], s57 offen nt
s_add_u32 s57, s57, 9216
buffer_load_dwordx4 v[92:95], v109, s[28:31], s57 offen nt
s_add_u32 s57, s57, 64512
buffer_load_dwordx4 v[96:99], v109, s[28:31], s57 offen nt
s_add_u32 s57, s57, 9216
buffer_load_dwordx4 v[100:103], v109, s[28:31], s57 offen nt
buffer_load_dwordx4 v[104:107], v109, s[28:31], s58 offen nt
s_waitcnt vmcnt(7)
ds_write_b128 v113, v[72:75] offset:8192
ds_write_b128 v113, v[76:79] offset:9216
s_waitcnt lgkmcnt(0)
s_barrier
ds_read_b64_tr_b16 v[72:73], v112 offset:8192
ds_read_b64_tr_b16 v[74:75], v112 offset:8704
ds_read_b64_tr_b16 v[76:77], v112 offset:12288
ds_read_b64_tr_b16 v[78:79], v112 offset:12800
s_waitcnt vmcnt(5)
ds_write_b128 v113, v[80:83] offset:0
ds_write_b128 v113, v[84:87] offset:1024
s_waitcnt lgkmcnt(0)
s_barrier
ds_read_b64_tr_b16 v[80:81], v112 offset:0
ds_read_b64_tr_b16 v[82:83], v112 offset:512
ds_read_b64_tr_b16 v[84:85], v112 offset:4096
ds_read_b64_tr_b16 v[86:87], v112 offset:4608
s_waitcnt vmcnt(3)
ds_write_b128 v113, v[88:91] offset:8192
ds_write_b128 v113, v[92:95] offset:9216
s_waitcnt lgkmcnt(0)
s_barrier
ds_read_b64_tr_b16 v[88:89], v112 offset:8192
ds_read_b64_tr_b16 v[90:91], v112 offset:8704
ds_read_b64_tr_b16 v[92:93], v112 offset:12288
ds_read_b64_tr_b16 v[94:95], v112 offset:12800
s_waitcnt vmcnt(1)
ds_write_b128 v113, v[96:99] offset:0
ds_write_b128 v113, v[100:103] offset:1024
s_waitcnt lgkmcnt(0)
s_barrier
ds_read_b64_tr_b16 v[96:97], v112 offset:0
ds_read_b64_tr_b16 v[98:99], v112 offset:512
ds_read_b64_tr_b16 v[100:101], v112 offset:4096
ds_read_b64_tr_b16 v[102:103], v112 offset:4608
s_waitcnt vmcnt(0)
ds_write_b128 v110, v[104:107] offset:8192
s_waitcnt lgkmcnt(0)
s_barrier
ds_read_b64_tr_b16 v[104:105], v112 offset:8192
ds_read_b64_tr_b16 v[106:107], v112 offset:8704
s_waitcnt lgkmcnt(0)
s_barrier
v_bfe_u32 v127, v0, 2, 1
v_lshl_add_u32 v127, v127, 8, v3
v_lshlrev_b32 v126, 3, v0
v_add_u32 v126, 152064, v126
v_and_b32 v4, 3, v0
v_lshlrev_b32 v4, 4, v4
v_bfe_u32 v13, v0, 4, 1
v_lshl_add_u32 v4, v13, 3, v4
v_lshrrev_b32 v13, 5, v0
v_lshl_add_u32 v4, v13, 6, v4
s_lshl_b32 s63, s49, 9
s_lshl_b32 s56, s3, 7
s_add_u32 s63, s63, s56
s_add_u32 s63, s63, s53
s_add_u32 s63, s63, 60928
s_lshl_b32 s55, s3, 10
s_add_u32 s55, s55, 147456
v_add_u32 v11, s55, v1
s_lshl_b32 s55, s3, 5
s_add_u32 s55, s55, 152064
v_lshl_add_u32 v5, v0, 3, s55
v_mov_b32 v12, 0
v_mov_b32 v13, 0
v_mov_b32 v14, 0x3f803f80
s_add_u32 s55, s69, 47104
s_cmp_eq_u32 s3, 0
s_cbranch_scc0 Lg1_139
v_and_b32 v10, 0x1ff, v1
s_add_u32 s56, s55, 4096
s_mov_b32 s52, 0
Lpoll_141:
buffer_load_dwordx4 v[108:111], v1, s[40:43], s55 offen sc1
buffer_load_dwordx4 v[112:115], v10, s[40:43], s56 offen sc1
s_waitcnt vmcnt(0)
v_max3_u32 v15, v108, v109, v110
v_max3_u32 v15, v15, v111, v112
v_max3_u32 v15, v15, v113, v114
v_max_u32 v15, v15, v115
v_cmp_eq_u32 vcc, -1, v15
s_cbranch_vccnz Lpretry_142
Lpdone_143:
s_branch Lgd_140
Lg1_139:
s_mov_b32 s52, 0
Lpoll_144:
buffer_load_dwordx4 v[108:111], v1, s[40:43], s55 offen sc1
s_waitcnt vmcnt(0)
v_max3_u32 v15, v108, v109, v110
v_max_u32 v15, v15, v111
v_cmp_eq_u32 vcc, -1, v15
s_cbranch_vccnz Lpretry_145
Lpdone_146:
Lgd_140:
ds_write_b128 v11, v[108:111]
v_dot2c_f32_bf16 v12, v108, v14
v_dot2c_f32_bf16 v13, v108, v108
v_dot2c_f32_bf16 v12, v109, v14
v_dot2c_f32_bf16 v13, v109, v109
v_dot2c_f32_bf16 v12, v110, v14
v_dot2c_f32_bf16 v13, v110, v110
v_dot2c_f32_bf16 v12, v111, v14
v_dot2c_f32_bf16 v13, v111, v111
s_cmp_eq_u32 s3, 0
s_cbranch_scc0 Lw_147
s_mov_b32 exec_hi, 0
ds_write_b128 v11, v[112:115] offset:4096
v_dot2c_f32_bf16 v12, v112, v14
v_dot2c_f32_bf16 v13, v112, v112
v_dot2c_f32_bf16 v12, v113, v14
v_dot2c_f32_bf16 v13, v113, v113
v_dot2c_f32_bf16 v12, v114, v14
v_dot2c_f32_bf16 v13, v114, v114
v_dot2c_f32_bf16 v12, v115, v14
v_dot2c_f32_bf16 v13, v115, v115
s_mov_b64 exec, -1
Lw_147:
s_nop 0
v_add_f32_dpp v12, v12, v12 row_ror:4 row_mask:0xf bank_mask:0xf
v_add_f32_dpp v13, v13, v13 row_ror:4 row_mask:0xf bank_mask:0xf
s_nop 0
v_add_f32_dpp v12, v12, v12 row_ror:8 row_mask:0xf bank_mask:0xf
v_add_f32_dpp v13, v13, v13 row_ror:8 row_mask:0xf bank_mask:0xf
s_mov_b64 exec, s[96:97]
ds_write_b64 v5, v[12:13]
s_mov_b64 exec, -1
s_waitcnt lgkmcnt(0)
s_barrier
ds_read_b64 v[10:11], v126
v_mov_b32 v5, v127
ds_read_b128 v[108:111], v5 offset:0
ds_read_b128 v[112:115], v5 offset:512
ds_read_b128 v[116:119], v5 offset:1024
s_waitcnt lgkmcnt(2)
v_mfma_f32_16x16x32_bf16 v[120:123], v[16:19], v[108:111], 0
v_add_f32_dpp v10, v10, v10 row_ror:4 row_mask:0xf bank_mask:0xf
v_add_f32_dpp v11, v11, v11 row_ror:4 row_mask:0xf bank_mask:0xf
s_nop 0
v_add_f32_dpp v10, v10, v10 row_ror:8 row_mask:0xf bank_mask:0xf
v_add_f32_dpp v11, v11, v11 row_ror:8 row_mask:0xf bank_mask:0xf
v_mfma_f32_16x16x32_bf16 v[124:127], v[20:23], v[108:111], 0
s_nop 0
v_permlane32_swap_b32 v10, v11
v_add_f32 v10, v10, v11
ds_read_b128 v[108:111], v5 offset:1536
s_waitcnt lgkmcnt(2)
v_mfma_f32_16x16x32_bf16 v[120:123], v[24:27], v[112:115], v[120:123]
v_mov_b32 v11, v10
s_nop 1
v_permlane16_swap_b32 v10, v11
v_mfma_f32_16x16x32_bf16 v[124:127], v[28:31], v[112:115], v[124:127]
v_add_f32 v10, v10, v11
v_mov_b32 v11, v10
ds_read_b128 v[112:115], v5 offset:2048
s_waitcnt lgkmcnt(2)
v_mfma_f32_16x16x32_bf16 v[120:123], v[32:35], v[116:119], v[120:123]
v_permlane32_swap_b32 v10, v11
v_mul_f32 v10, 0x3ae38e39, v10
v_mfma_f32_16x16x32_bf16 v[124:127], v[36:39], v[116:119], v[124:127]
v_mul_f32 v11, 0x3ae38e39, v11
v_fma_f32 v11, -v10, v10, v11
ds_read_b128 v[116:119], v5 offset:2560
s_waitcnt lgkmcnt(2)
v_mfma_f32_16x16x32_bf16 v[120:123], v[40:43], v[108:111], v[120:123]
v_max_f32 v11, 0, v11
v_add_f32 v11, 0x3727c5ac, v11
v_mfma_f32_16x16x32_bf16 v[124:127], v[44:47], v[108:111], v[124:127]
v_rsq_f32 v11, v11
v_mul_f32 v12, v10, v6
ds_read_b128 v[108:111], v5 offset:3072
s_waitcnt lgkmcnt(2)
v_mfma_f32_16x16x32_bf16 v[120:123], v[48:51], v[112:115], v[120:123]
v_mul_f32 v13, v10, v7
v_mul_f32 v14, v10, v8
v_mfma_f32_16x16x32_bf16 v[124:127], v[52:55], v[112:115], v[124:127]
v_mul_f32 v15, v10, v9
ds_read_b128 v[112:115], v5 offset:3584
s_waitcnt lgkmcnt(2)
v_mfma_f32_16x16x32_bf16 v[120:123], v[56:59], v[116:119], v[120:123]
v_mfma_f32_16x16x32_bf16 v[124:127], v[60:63], v[116:119], v[124:127]
ds_read_b128 v[116:119], v5 offset:4096
s_waitcnt lgkmcnt(2)
v_mfma_f32_16x16x32_bf16 v[120:123], v[64:67], v[108:111], v[120:123]
v_mfma_f32_16x16x32_bf16 v[124:127], v[68:71], v[108:111], v[124:127]
s_waitcnt lgkmcnt(1)
v_mfma_f32_16x16x32_bf16 v[120:123], a[240:243], v[112:115], v[120:123]
v_mfma_f32_16x16x32_bf16 v[124:127], a[244:247], v[112:115], v[124:127]
s_waitcnt lgkmcnt(0)
v_mfma_f32_16x16x32_bf16 v[120:123], a[248:251], v[116:119], v[120:123]
v_mfma_f32_16x16x32_bf16 v[124:127], a[252:255], v[116:119], v[124:127]
s_nop 7
v_add_f32_dpp v120, v124, v120 row_shl:4 row_mask:0xf bank_mask:0xf
v_add_f32_dpp v121, v125, v121 row_shl:4 row_mask:0xf bank_mask:0xf
v_add_f32_dpp v122, v126, v122 row_shl:4 row_mask:0xf bank_mask:0xf
v_add_f32_dpp v123, v127, v123 row_shl:4 row_mask:0xf bank_mask:0xf
v_sub_f32 v120, v120, v12
v_sub_f32 v121, v121, v13
v_sub_f32 v122, v122, v14
v_sub_f32 v123, v123, v15
v_mul_f32 v120, v11, v120
v_mul_f32 v121, v11, v121
v_mul_f32 v122, v11, v122
v_mul_f32 v123, v11, v123
s_cmp_eq_u32 s62, 0
s_cbranch_scc0 Lup_148
v_mul_f32 v124, 0xbfb8aa3b, v120
v_mul_f32 v125, 0xbfb8aa3b, v121
v_mul_f32 v126, 0xbfb8aa3b, v122
v_mul_f32 v127, 0xbfb8aa3b, v123
v_exp_f32 v124, v124
v_exp_f32 v125, v125
v_exp_f32 v126, v126
v_exp_f32 v127, v127
v_add_f32 v124, 1.0, v124
v_add_f32 v125, 1.0, v125
v_add_f32 v126, 1.0, v126
v_add_f32 v127, 1.0, v127
v_rcp_f32 v124, v124
v_rcp_f32 v125, v125
v_rcp_f32 v126, v126
v_rcp_f32 v127, v127
v_mul_f32 v120, v120, v124
v_mul_f32 v121, v121, v125
v_mul_f32 v122, v122, v126
v_mul_f32 v123, v123, v127
Lup_148:
v_cvt_pk_bf16_f32 v120, v120, v121
v_cvt_pk_bf16_f32 v121, v122, v123
s_mov_b64 exec, s[96:97]
s_cmp_eq_u32 s50, 1
s_cbranch_scc0 Lpl_149
buffer_store_dwordx2 v[120:121], v4, s[40:43], s63 offen
Lpe_150:
s_mov_b64 exec, -1
s_lshl_b32 s56, s3, 11
s_add_u32 s56, s56, 155648
v_add_u32 v4, s56, v1
s_lshl_b32 s61, s49, 1
s_add_u32 s61, s61, s3
s_cmp_lt_u32 s3, 2
s_cbranch_scc0 Lw_151
v_mov_b32 v13, 0
v_lshrrev_b32 v10, 4, v0
v_bfe_u32 v11, v0, 2, 2
v_and_b32 v14, 3, v0
v_lshlrev_b32 v12, 4, v14
v_and_b32 v15, 1, v11
v_lshl_add_u32 v12, v15, 3, v12
v_lshrrev_b32 v15, 1, v11
v_lshl_add_u32 v12, v15, 6, v12
v_lshl_add_u32 v5, v10, 1, v12
s_lshl_b32 s55, s61, 7
s_add_u32 s55, s55, s53
s_add_u32 s55, s55, 47104
buffer_load_short_d16_hi v13, v5, s[40:43], s55 offen sc1
v_mul_u32_u24 v12, 1152, v14
v_lshl_add_u32 v12, v11, 3, v12
v_lshrrev_b32 v10, 5, v0
v_lshl_add_u32 v12, v10, 2, v12
s_lshl_b32 s63, s61, 5
Lw_151:
s_mul_i32 s55, s62, 2304
s_add_u32 s55, s55, s69
s_add_u32 s55, s55, 60928
s_lshl_b32 s56, s3, 10
s_add_u32 s56, s56, 147456
v_add_u32 v10, s56, v1
v_bfe_u32 v5, v0, 2, 1
v_lshl_add_u32 v5, v5, 8, v3
v_lshrrev_b32 v11, 4, v0
v_lshlrev_b32 v11, 6, v11
v_and_b32 v14, 3, v0
v_lshl_add_u32 v11, v14, 4, v11
s_add_u32 s58, s68, 442368
s_barrier
s_cmp_eq_u32 s3, 3
s_cbranch_scc1 Lh3_152
s_cmp_eq_u32 s3, 2
s_cbranch_scc0 Lh2_153
s_mov_b64 exec, 0xffff
Lh2_153:
s_add_u32 s56, s55, 4608
s_mov_b32 s52, 0
Lpoll_154:
buffer_load_dwordx4 v[108:111], v1, s[40:43], s55 offen sc1
buffer_load_dwordx4 v[112:115], v1, s[40:43], s56 offen sc1
s_waitcnt vmcnt(0)
v_max3_u32 v15, v108, v110, v112
v_max_u32 v15, v15, v114
v_cmp_eq_u32 vcc, -1, v15
s_cbranch_vccnz Lpretry_155
Lpdone_156:
v_and_b32 v116, 0xffff, v112
v_and_b32 v117, 0xffff, v113
v_and_b32 v118, 0xffff, v114
v_and_b32 v119, 0xffff, v115
v_and_b32 v112, 0xffff0000, v112
v_and_b32 v113, 0xffff0000, v113
v_and_b32 v114, 0xffff0000, v114
v_and_b32 v115, 0xffff0000, v115
v_dot2_f32_bf16 v116, v108, v116, 0
v_dot2_f32_bf16 v117, v109, v117, 0
v_dot2_f32_bf16 v118, v110, v118, 0
v_dot2_f32_bf16 v119, v111, v119, 0
v_dot2_f32_bf16 v112, v108, v112, 0
v_dot2_f32_bf16 v113, v109, v113, 0
v_dot2_f32_bf16 v114, v110, v114, 0
v_dot2_f32_bf16 v115, v111, v115, 0
v_cvt_pk_bf16_f32 v108, v116, v112
v_cvt_pk_bf16_f32 v109, v117, v113
v_cvt_pk_bf16_f32 v110, v118, v114
v_cvt_pk_bf16_f32 v111, v119, v115
ds_write_b128 v10, v[108:111]
s_mov_b64 exec, -1
s_waitcnt lgkmcnt(0)
Lh3_152:
s_barrier
ds_read_b128 v[108:111], v5 offset:0
ds_read_b128 v[112:115], v5 offset:512
ds_read_b128 v[116:119], v5 offset:1024
s_waitcnt lgkmcnt(2)
v_mfma_f32_16x16x32_bf16 v[120:123], v[72:75], v[108:111], 0
v_mfma_f32_16x16x32_bf16 v[124:127], v[76:79], v[108:111], 0
ds_read_b128 v[108:111], v5 offset:1536
s_waitcnt lgkmcnt(2)
v_mfma_f32_16x16x32_bf16 v[120:123], v[80:83], v[112:115], v[120:123]
v_mfma_f32_16x16x32_bf16 v[124:127], v[84:87], v[112:115], v[124:127]
ds_read_b128 v[112:115], v5 offset:2048
s_waitcnt lgkmcnt(2)
v_mfma_f32_16x16x32_bf16 v[120:123], v[88:91], v[116:119], v[120:123]
v_mfma_f32_16x16x32_bf16 v[124:127], v[92:95], v[116:119], v[124:127]
s_waitcnt lgkmcnt(1)
v_mfma_f32_16x16x32_bf16 v[120:123], v[96:99], v[108:111], v[120:123]
v_mfma_f32_16x16x32_bf16 v[124:127], v[100:103], v[108:111], v[124:127]
s_waitcnt lgkmcnt(0)
v_mfma_f32_16x16x32_bf16 v[120:123], v[104:107], v[112:115], v[120:123]
s_nop 7
v_add_f32_dpp v120, v124, v120 row_shl:4 row_mask:0xf bank_mask:0xf
v_add_f32_dpp v121, v125, v121 row_shl:4 row_mask:0xf bank_mask:0xf
v_add_f32_dpp v122, v126, v122 row_shl:4 row_mask:0xf bank_mask:0xf
v_add_f32_dpp v123, v127, v123 row_shl:4 row_mask:0xf bank_mask:0xf
s_mov_b64 exec, s[96:97]
buffer_store_dwordx4 v[120:123], v11, s[40:43], s58 offen sc1
s_mov_b64 exec, -1
s_cmp_ge_u32 s3, 2
s_cbranch_scc1 L_end
s_and_b32 s55, s61, 7
s_cmp_eq_u32 s55, s48
s_cbranch_scc0 L_end
s_lshl_b32 s55, s61, 12
s_add_u32 s55, s55, 1032192
s_waitcnt vmcnt(0)
s_mov_b32 s52, 0
Lpoll_157:
buffer_load_dwordx4 v[72:75], v1, s[40:43], s55 offen offset:0 sc1
buffer_load_dwordx4 v[76:79], v1, s[40:43], s55 offen offset:1024 sc1
buffer_load_dwordx4 v[80:83], v1, s[40:43], s55 offen offset:2048 sc1
buffer_load_dwordx4 v[84:87], v1, s[40:43], s55 offen offset:3072 sc1
s_waitcnt vmcnt(0)
v_max3_u32 v15, v72, v76, v80
v_max_u32 v15, v15, v84
v_cmp_eq_u32 vcc, -1, v15
s_cbranch_vccnz Lpretry_158
Lpdone_159:
v_add_f32 v72, v72, v76
v_add_f32 v80, v80, v84
v_add_f32 v73, v73, v77
v_add_f32 v81, v81, v85
v_add_f32 v74, v74, v78
v_add_f32 v82, v82, v86
v_add_f32 v75, v75, v79
v_add_f32 v83, v83, v87
v_add_f32 v72, v72, v80
v_add_f32 v74, v74, v82
v_add_f32 v73, v73, v81
v_add_f32 v75, v75, v83
v_permlane32_swap_b32 v72, v74
s_nop 0
v_permlane32_swap_b32 v73, v75
v_add_f32 v72, v72, v74
v_add_f32 v73, v73, v75
s_nop 1
v_permlane16_swap_b32 v72, v73
v_add_f32 v72, v72, v73
v_cvt_pk_bf16_f32 v72, v72, v72
v_and_b32 v72, 0xffff0000, v72
v_add_f32 v72, v72, v13
v_mov_b32 v73, v72
s_nop 1
v_permlane16_swap_b32 v72, v73
v_cvt_pk_bf16_f32 v72, v72, v73
s_mov_b32 exec_lo, 0xffff
s_mov_b32 exec_hi, 0xffff
buffer_store_dword v72, v12, s[36:39], s63 offen
s_mov_b64 exec, -1
L_end:
s_endpgm
Lpretry_32:
s_add_u32 s52, s52, 1
s_cmp_lt_u32 s52, s51
s_cbranch_scc1 Lpoll_31
s_mov_b32 s51, 0
s_branch Lpdone_33
Lpretry_44:
s_add_u32 s52, s52, 1
s_cmp_lt_u32 s52, s51
s_cbranch_scc1 Lpoll_43
s_mov_b32 s51, 0
s_branch Lpdone_45
Lpl_47:
buffer_store_dwordx2 v[120:121], v12, s[40:43], s55 offen sc1
s_mov_b64 exec, 1
buffer_store_dwordx4 v[96:99], v14, s[40:43], s58 offen sc1
s_branch Lpe_48
Lpretry_56:
s_add_u32 s52, s52, 1
s_cmp_lt_u32 s52, s51
s_cbranch_scc1 Lpoll_55
s_mov_b32 s51, 0
s_branch Lpdone_57
Lpretry_59:
s_add_u32 s52, s52, 1
s_cmp_lt_u32 s52, s51
s_cbranch_scc1 Lpoll_58
s_mov_b32 s51, 0
s_branch Lpdone_60
Lpretry_65:
s_add_u32 s52, s52, 1
s_cmp_lt_u32 s52, s51
s_cbranch_scc1 Lpoll_64
s_mov_b32 s51, 0
s_branch Lpdone_66
Lpl_67:
buffer_store_dword v72, v12, s[40:43], s63 offen sc1
s_branch Lpe_68
Lpretry_70:
s_sleep 4
s_add_u32 s52, s52, 1
s_cmp_lt_u32 s52, s51
s_cbranch_scc1 Lpoll_69
s_mov_b32 s51, 0
s_branch Lpdone_71
Lpretry_76:
s_sleep 1
s_add_u32 s52, s52, 1
s_cmp_lt_u32 s52, s51
s_cbranch_scc1 Lpoll_75
s_mov_b32 s51, 0
s_branch Lpdone_77
Lpretry_79:
s_sleep 1
s_add_u32 s52, s52, 1
s_cmp_lt_u32 s52, s51
s_cbranch_scc1 Lpoll_78
s_mov_b32 s51, 0
s_branch Lpdone_80
Lpl_83:
buffer_store_dwordx2 v[120:121], v4, s[40:43], s63 offen sc1
s_branch Lpe_84
Lpretry_89:
s_add_u32 s52, s52, 1
s_cmp_lt_u32 s52, s51
s_cbranch_scc1 Lpoll_88
s_mov_b32 s51, 0
s_branch Lpdone_90
Lpretry_94:
s_add_u32 s52, s52, 1
s_cmp_lt_u32 s52, s51
s_cbranch_scc1 Lpoll_93
s_mov_b32 s51, 0
s_branch Lpdone_95
Lpl_96:
buffer_store_dword v72, v12, s[40:43], s63 offen sc1
s_branch Lpe_97
Lpretry_103:
s_sleep 1
s_add_u32 s52, s52, 1
s_cmp_lt_u32 s52, s51
s_cbranch_scc1 Lpoll_102
s_mov_b32 s51, 0
s_branch Lpdone_104
Lpretry_106:
s_sleep 1
s_add_u32 s52, s52, 1
s_cmp_lt_u32 s52, s51
s_cbranch_scc1 Lpoll_105
s_mov_b32 s51, 0
s_branch Lpdone_107
Lpl_111:
buffer_store_dwordx2 v[120:121], v5, s[40:43], s63 offen sc1
s_branch Lpe_112
Lpretry_114:
s_add_u32 s52, s52, 1
s_cmp_lt_u32 s52, s51
s_cbranch_scc1 Lpoll_113
s_mov_b32 s51, 0
s_branch Lpdone_115
Lpl_117:
buffer_store_dwordx2 v[120:121], v12, s[40:43], s55 offen sc1
s_mov_b64 exec, 1
buffer_store_dwordx4 v[96:99], v14, s[40:43], s58 offen sc1
s_branch Lpe_118
Lpretry_126:
s_add_u32 s52, s52, 1
s_cmp_lt_u32 s52, s51
s_cbranch_scc1 Lpoll_125
s_mov_b32 s51, 0
s_branch Lpdone_127
Lpretry_129:
s_add_u32 s52, s52, 1
s_cmp_lt_u32 s52, s51
s_cbranch_scc1 Lpoll_128
s_mov_b32 s51, 0
s_branch Lpdone_130
Lpretry_135:
s_add_u32 s52, s52, 1
s_cmp_lt_u32 s52, s51
s_cbranch_scc1 Lpoll_134
s_mov_b32 s51, 0
s_branch Lpdone_136
Lpl_137:
buffer_store_dword v72, v12, s[40:43], s63 offen sc1
s_branch Lpe_138
Lpretry_142:
s_sleep 1
s_add_u32 s52, s52, 1
s_cmp_lt_u32 s52, s51
s_cbranch_scc1 Lpoll_141
s_mov_b32 s51, 0
s_branch Lpdone_143
Lpretry_145:
s_sleep 1
s_add_u32 s52, s52, 1
s_cmp_lt_u32 s52, s51
s_cbranch_scc1 Lpoll_144
s_mov_b32 s51, 0
s_branch Lpdone_146
Lpl_149:
buffer_store_dwordx2 v[120:121], v4, s[40:43], s63 offen sc1
s_branch Lpe_150
Lpretry_155:
s_add_u32 s52, s52, 1
s_cmp_lt_u32 s52, s51
s_cbranch_scc1 Lpoll_154
s_mov_b32 s51, 0
s_branch Lpdone_156
Lpretry_158:
s_add_u32 s52, s52, 1
s_cmp_lt_u32 s52, s51
s_cbranch_scc1 Lpoll_157
s_mov_b32 s51, 0
s_branch Lpdone_159
L_code_end:
.section .rodata,"a"
.p2align 6
.amdhsa_kernel interleave_layers__gqa_block_cached__glu_gated_swiglu__decode_kernel
.amdhsa_next_free_vgpr 512
.amdhsa_next_free_sgpr 102
.amdhsa_accum_offset 256
.amdhsa_group_segment_fixed_size 0
.amdhsa_kernarg_size 96
.amdhsa_user_sgpr_count 2
.amdhsa_user_sgpr_kernarg_segment_ptr 1
.amdhsa_system_sgpr_workgroup_id_x 1
.end_amdhsa_kernel
```
